```python
import torch

def _softmax(x, axis=-1):
    return torch.softmax(x, dim=axis)
def _gelu(x):
    return torch.nn.functional.gelu(x, approximate="tanh")
def _silu(x):
    return torch.nn.functional.silu(x)
def _sigmoid(x):
    return torch.sigmoid(x)
def _layernorm(x, axis=-1, eps=1e-5):
    m = x.mean(dim=axis, keepdim=True)
    v = x.var(dim=axis, keepdim=True, unbiased=False)
    return (x - m) / torch.sqrt(v + eps)
def _scatter_add(tgt, idx, src, axis=0):
    return tgt.clone().index_add_(axis, idx, src)
def _segment_sum(src, seg, n):
    out = torch.zeros((n,) + src.shape[1:], dtype=src.dtype)
    return out.index_add_(0, seg, src)
def _pad(x, pw):
    flat = tuple(v for pair in reversed(pw) for v in pair)
    return torch.nn.functional.pad(x, flat)

kernel_name = 'concat_heads__mha_block_cached__gqa_block_cached__near_ridge'

def setup_inputs():

    _w = (lambda a: (lambda t: t.to(torch.bfloat16) if t.is_floating_point() else t)(torch.as_tensor(a)))
    def _A_setup():
        B, Sq, D = 8, 192, 640
        H, Sk, Dh = 32, 512, 128
        return {
            "x": _w((lambda *s: torch.randn(*s, dtype=torch.bfloat16) * 0.8)(B, Sq, D)),
            "k_cache": _w((lambda *s: torch.randn(*s, dtype=torch.bfloat16) * 0.8)(B, H, Sk, Dh)),
            "v_cache": _w((lambda *s: torch.randn(*s, dtype=torch.bfloat16) * 0.05)(B, H, Sk, Dh)),
            "wq": _w((lambda *s: torch.randn(*s, dtype=torch.bfloat16) * 0.8)(D, H * Dh) * (D ** -0.5)),
            "wo": _w((lambda *s: torch.randn(*s, dtype=torch.bfloat16) * 0.05)(H * Dh, D) * ((H * Dh) ** -0.5)),
        }
    _A_in = _A_setup()

    def _B_setup():
        B, Sq, D = 8, 192, 640
        Hq, Hkv, Sk, Dh = 32, 32, 512, 128
        assert Hq % Hkv == 0, (Hq, Hkv)
        return {
            "x": _w((lambda *s: torch.randn(*s, dtype=torch.bfloat16) * 0.8)(B, Sq, D)),
            "k_cache": _w((lambda *s: torch.randn(*s, dtype=torch.bfloat16) * 0.8)(B, Hkv, Sk, Dh)),
            "v_cache": _w((lambda *s: torch.randn(*s, dtype=torch.bfloat16) * 0.05)(B, Hkv, Sk, Dh)),
            "wq": _w((lambda *s: torch.randn(*s, dtype=torch.bfloat16) * 0.8)(D, Hq * Dh) * (D ** -0.5)),
            "wo": _w((lambda *s: torch.randn(*s, dtype=torch.bfloat16) * 0.05)(Hq * Dh, D) * ((Hq * Dh) ** -0.5)),
        }
    _B_in = _B_setup()

    return {
        "A_x": _A_in["x"],
        "A_k_cache": _A_in["k_cache"],
        "A_v_cache": _A_in["v_cache"],
        "A_wq": _A_in["wq"],
        "A_wo": _A_in["wo"],
        "B_x": _B_in["x"],
        "B_k_cache": _B_in["k_cache"],
        "B_v_cache": _B_in["v_cache"],
        "B_wq": _B_in["wq"],
        "B_wo": _B_in["wo"],
    }

def reference(A_x, A_k_cache, A_v_cache, A_wq, A_wo, B_x, B_k_cache, B_v_cache, B_wq, B_wo):
    def _A_ref(x, k_cache, v_cache, wq, wo):
        B, Sq, D = x.shape
        H, Dh = 32, 128
        q = (lambda x, *d: x.permute(*d))((x @ wq).reshape(B, Sq, H, Dh), 0, 2, 1, 3)
        scores = torch.einsum("bhqd,bhkd->bhqk", q, k_cache) * (Dh ** -0.5)
        p = _softmax(scores, axis=-1)
        o = torch.einsum("bhqk,bhkd->bhqd", p, v_cache)
        return (lambda x, *d: x.permute(*d))(o, 0, 2, 1, 3).reshape(B, Sq, H * Dh) @ wo

    def _B_ref(x, k_cache, v_cache, wq, wo):
        B, Sq, D = x.shape
        Hq, Dh = 32, 128
        Hkv = k_cache.shape[1]
        rep = Hq // Hkv
        q = (lambda x, *d: x.permute(*d))((x @ wq).reshape(B, Sq, Hq, Dh), 0, 2, 1, 3)
        k = (lambda x, n, axis: torch.repeat_interleave(x, n, dim=axis))(k_cache, rep, axis=1)
        v = (lambda x, n, axis: torch.repeat_interleave(x, n, dim=axis))(v_cache, rep, axis=1)
        scores = torch.einsum("bhqd,bhkd->bhqk", q, k) * (Dh ** -0.5)
        p = _softmax(scores, axis=-1)
        o = torch.einsum("bhqk,bhkd->bhqd", p, v)
        return (lambda x, *d: x.permute(*d))(o, 0, 2, 1, 3).reshape(B, Sq, Hq * Dh) @ wo

    a = _A_ref(A_x, A_k_cache, A_v_cache, A_wq, A_wo)
    b = _B_ref(B_x, B_k_cache, B_v_cache, B_wq, B_wo)
    return torch.concatenate([a, b], axis=-1)
```

```asm
; @launch grid=(256,1,1) block=(512,1,1) lds=163840
.amdgcn_target "amdgcn-amd-amdhsa--gfx950"
.text
.globl concat_heads__mha_block_cached__gqa_block_cached__near_ridge_kernel
.p2align 8
.type concat_heads__mha_block_cached__gqa_block_cached__near_ridge_kernel,@function
concat_heads__mha_block_cached__gqa_block_cached__near_ridge_kernel:
    s_cmp_ge_u32 s2, 256
    s_cbranch_scc1 L_end
    s_load_dwordx2 s[62:63], s[0:1], 88
    s_load_dwordx8 s[44:51], s[0:1], 0
    s_load_dwordx8 s[52:59], s[0:1], 40
    s_load_dwordx2 s[60:61], s[0:1], 96
    v_lshrrev_b32 v11, 6, v0
    v_and_b32 v12, 63, v0
    v_readfirstlane_b32 s3, v11
    s_getreg_b32 s5, hwreg(HW_REG_XCC_ID, 0, 4)
    s_nop 1
    s_cmp_eq_u32 s3, 1
    s_cbranch_scc0 L_nocodepf
    s_getpc_b64 s[40:41]
L_pc_here:
    s_mov_b32 s42, L_end-L_pc_here
    v_lshlrev_b32 v24, 7, v12
    v_min_u32 v26, s42, v24
    global_load_dword v127, v26, s[40:41]
    v_add_u32 v24, 8192, v24
    v_min_u32 v26, s42, v24
    global_load_dword v127, v26, s[40:41]
    v_add_u32 v24, 8192, v24
    v_min_u32 v26, s42, v24
    global_load_dword v127, v26, s[40:41]
    v_add_u32 v24, 8192, v24
    v_min_u32 v26, s42, v24
    global_load_dword v127, v26, s[40:41]
    v_add_u32 v24, 8192, v24
    v_min_u32 v26, s42, v24
    global_load_dword v127, v26, s[40:41]
    v_add_u32 v24, 8192, v24
L_nocodepf:
    s_lshr_b32 s4, s3, 2
    s_and_b32 s74, s3, 3
    v_and_b32 v13, 15, v12
    v_lshrrev_b32 v14, 4, v12
    s_mul_i32 s40, s3, 24
    v_lshrrev_b32 v15, 3, v12
    v_add_u32 v15, s40, v15
    v_bfe_u32 v11, v15, 1, 3
    v_and_b32 v16, 7, v12
    v_xor_b32 v11, v11, v16
    v_lshlrev_b32 v11, 4, v11
    v_mul_u32_u24 v15, 1280, v15
    v_add_u32 v122, v15, v11
    v_xor_b32 v11, 64, v11
    v_add_u32 v123, v15, v11
    v_lshrrev_b32 v15, 5, v12
    s_bfe_u32 s40, s3, 0x10001
    s_lshl_b32 s40, s40, 3
    v_or_b32 v11, s40, v15
    v_xor_b32 v11, v11, v13
    v_lshlrev_b32 v11, 4, v11
    v_bfe_u32 v16, v12, 4, 1
    v_lshl_or_b32 v11, v16, 8, v11
    s_lshl_b32 s40, s3, 2
    v_add_u32 v15, s40, v15
    v_lshlrev_b32 v15, 13, v15
    v_add_u32 v124, v15, v11
    v_xor_b32 v11, 64, v11
    v_add_u32 v11, 16384, v11
    v_add_u32 v125, v15, v11
    s_and_b32 s8, s2, 7
    s_lshr_b32 s6, s8, 2
    s_and_b32 s8, s8, 3
    s_lshr_b32 s10, s2, 3
    s_and_b32 s7, s10, 7
    s_lshr_b32 s10, s10, 3
    s_lshl_b32 s9, s8, 3
    s_lshl_b32 s11, s10, 1
    s_add_u32 s9, s9, s11
    s_waitcnt lgkmcnt(0)
    s_cmp_eq_u32 s6, 0
    s_cselect_b64 s[12:13], s[44:45], s[52:53]
    s_cselect_b64 s[18:19], s[50:51], s[58:59]
    s_cselect_b64 s[14:15], s[46:47], s[54:55]
    s_cselect_b64 s[16:17], s[48:49], s[56:57]
    s_mul_i32 s40, s7, 245760
    s_add_u32 s20, s12, s40
    s_addc_u32 s21, s13, 0
    s_mov_b32 s22, 245760
    s_mov_b32 s23, 0x20000
    s_lshl_b32 s40, s9, 8
    s_add_u32 s24, s18, s40
    s_addc_u32 s25, s19, 0
    s_sub_u32 s26, 5242880, s40
    s_mov_b32 s27, 0x20000
    s_lshl_b32 s11, s6, 2
    s_add_u32 s11, s11, s8
    s_lshl_b32 s11, s11, 3
    s_add_u32 s11, s11, s7
    s_cmp_eq_u32 s3, 0
    s_cbranch_scc0 L_nozero
    s_lshl_b32 s40, s11, 7
    s_lshl_b32 s41, s10, 2
    s_add_u32 s40, s40, s41
    s_add_u32 s40, s40, 50331648
    v_mov_b32 v11, s40
    v_mov_b32 v15, 0
    s_mov_b64 exec, 1
    global_store_dword v11, v15, s[60:61]
    s_mov_b64 exec, -1
L_nozero:
    s_mul_i32 s64, s3, 3072
    s_add_u32 s64, s64, 16384
    s_lshl_b32 s65, s3, 11
    s_add_u32 s65, s65, 98304
    s_mov_b32 s72, 0
    s_lshl_b32 s70, s72, 7
    s_lshl_b32 s71, s72, 19
    s_add_u32 m0, s64, 0
    s_add_u32 s40, s70, 0
    buffer_load_dwordx4 v122, s[20:23], s40 offen lds
    s_add_u32 m0, s64, 1024
    s_add_u32 s40, s70, 10240
    buffer_load_dwordx4 v123, s[20:23], s40 offen lds
    s_add_u32 m0, s64, 2048
    s_add_u32 s40, s70, 20480
    buffer_load_dwordx4 v122, s[20:23], s40 offen lds
    s_add_u32 s70, s70, 128
    s_cmp_eq_u32 s70, 1280
    s_cselect_b32 s70, 0, s70
    s_add_u32 m0, s65, 0
    s_nop 0
    buffer_load_dwordx4 v124, s[24:27], s71 offen lds
    s_add_u32 m0, s65, 1024
    s_nop 0
    buffer_load_dwordx4 v125, s[24:27], s71 offen lds
    s_add_u32 s71, s71, 262144
    s_cmp_eq_u32 s71, 5242880
    s_cselect_b32 s71, 0, s71
    s_add_u32 m0, s65, 16384
    s_nop 0
    buffer_load_dwordx4 v124, s[24:27], s71 offen lds
    s_add_u32 m0, s65, 17408
    s_nop 0
    buffer_load_dwordx4 v125, s[24:27], s71 offen lds
    s_add_u32 s71, s71, 262144
    s_cmp_eq_u32 s71, 5242880
    s_cselect_b32 s71, 0, s71
    s_add_u32 m0, s64, 24576
    s_add_u32 s40, s70, 0
    buffer_load_dwordx4 v122, s[20:23], s40 offen lds
    s_add_u32 m0, s64, 25600
    s_add_u32 s40, s70, 10240
    buffer_load_dwordx4 v123, s[20:23], s40 offen lds
    s_add_u32 m0, s65, 32768
    s_nop 0
    buffer_load_dwordx4 v124, s[24:27], s71 offen lds
    s_add_u32 m0, s65, 33792
    s_nop 0
    buffer_load_dwordx4 v125, s[24:27], s71 offen lds
    s_add_u32 s71, s71, 262144
    s_cmp_eq_u32 s71, 5242880
    s_cselect_b32 s71, 0, s71
    s_add_u32 m0, s64, 26624
    s_add_u32 s40, s70, 20480
    buffer_load_dwordx4 v122, s[20:23], s40 offen lds
    s_add_u32 s70, s70, 128
    s_cmp_eq_u32 s70, 1280
    s_cselect_b32 s70, 0, s70
    s_mov_b32 m0, 65536
    s_mov_b32 s40, 2130706432
    buffer_load_dword v124, s[24:27], s40 offen lds
    s_lshl_b32 s9, s10, 1
    s_lshl_b32 s40, s8, 3
    s_add_u32 s9, s9, s40
    s_add_u32 s9, s9, s4
    s_lshl_b32 s40, s7, 5
    s_add_u32 s40, s40, s9
    s_lshr_b32 s41, s40, 15
    s_lshl_b32 s42, s40, 17
    s_add_u32 s28, s14, s42
    s_addc_u32 s29, s15, s41
    s_mov_b32 s30, 131072
    s_mov_b32 s31, 0x20000
    s_add_u32 s32, s16, s42
    s_addc_u32 s33, s17, s41
    s_mov_b32 s34, 131072
    s_mov_b32 s35, 0x20000
    s_load_dwordx2 s[52:53], s[0:1], 32
    s_load_dwordx2 s[54:55], s[0:1], 72
    s_load_dwordx2 s[56:57], s[0:1], 80
    s_lshl_b32 s42, s6, 8
    s_add_u32 s42, s42, s40
    s_mul_i32 s42, s42, 49152
    s_mul_i32 s43, s74, 12288
    s_add_u32 s42, s42, s43
    s_add_u32 s36, s60, s42
    s_addc_u32 s37, s61, 0
    s_mov_b32 s38, 12288
    s_mov_b32 s39, 0x20000
    s_mul_i32 s75, s4, 81920
    s_mul_i32 s40, s74, 48
    v_add_u32 v15, s40, v13
    v_lshlrev_b32 v15, 7, v15
    v_lshrrev_b32 v11, 1, v13
    v_xor_b32 v11, v11, v14
    v_lshl_add_u32 v15, v11, 4, v15
    v_add_u32 v120, 16384, v15
    v_xor_b32 v121, 64, v120
    v_lshrrev_b32 v15, 2, v13
    v_and_b32 v16, 3, v13
    v_and_b32 v11, 1, v15
    v_lshrrev_b32 v17, 1, v15
    v_lshl_or_b32 v11, v17, 2, v11
    v_and_b32 v17, 1, v14
    v_lshl_or_b32 v11, v17, 3, v11
    v_xor_b32 v11, v11, v16
    v_lshlrev_b32 v11, 4, v11
    v_and_b32 v18, 1, v16
    v_lshl_or_b32 v11, v18, 3, v11
    v_lshl_add_u32 v18, v14, 3, v15
    v_lshl_add_u32 v11, v18, 9, v11
    s_lshl_b32 s40, s4, 8
    s_add_u32 s40, s40, 98304
    v_add_u32 v112, s40, v11
    v_xor_b32 v113, 8, v112
    v_xor_b32 v114, 64, v112
    v_xor_b32 v115, 72, v112
    v_xor_b32 v116, 128, v112
    v_xor_b32 v117, 136, v112
    v_xor_b32 v118, 192, v112
    v_xor_b32 v119, 200, v112
    v_lshlrev_b32 v11, 10, v15
    v_lshl_add_u32 v11, v16, 8, v11
    v_xor_b32 v18, v14, v16
    v_lshl_add_u32 v11, v18, 4, v11
    v_lshl_add_u32 v11, v15, 6, v11
    v_add_u32 v1, s75, v11
    v_xor_b32 v2, 64, v1
    v_xor_b32 v3, 128, v1
    v_xor_b32 v4, 192, v1
    v_lshlrev_b32 v11, 10, v14
    v_lshl_add_u32 v11, v15, 5, v11
    v_lshl_add_u32 v11, v16, 3, v11
    s_add_u32 s40, s75, 40960
    v_add_u32 v11, s40, v11
    v_lshlrev_b32 v18, 7, v17
    v_add_u32 v5, v11, v18
    v_sub_u32 v6, v11, v18
    v_cmp_eq_u32 s[66:67], 1, v17
    v_lshlrev_b32 v0, 4, v12
    s_lshl_b32 s40, s74, 1
    s_and_b32 s40, s40, 3
    s_lshl_b32 s40, s40, 2
    v_xor_b32 v11, v13, v14
    v_xor_b32 v11, s40, v11
    v_lshlrev_b32 v11, 4, v11
    v_lshl_add_u32 v11, v14, 8, v11
    s_lshl_b32 s40, s74, 11
    v_add_u32 v7, s40, v11
    v_xor_b32 v11, 64, v11
    v_add_u32 v11, 1024, v11
    v_add_u32 v8, s40, v11
    v_lshrrev_b32 v11, 3, v12
    v_lshlrev_b32 v11, 5, v11
    v_bfe_u32 v14, v12, 1, 2
    v_lshl_add_u32 v11, v14, 8, v11
    v_and_b32 v14, 1, v12
    v_lshl_add_u32 v11, v14, 4, v11
    v_add_u32 v9, s40, v11
    v_xor_b32 v11, 32, v11
    v_add_u32 v11, 1024, v11
    v_add_u32 v10, s40, v11
    s_mov_b32 s68, 1040356334
    s_mov_b32 s69, 1040356334
    s_lshl_b32 s76, s74, 11
    s_add_u32 s76, s76, s75
    s_add_u32 s77, s76, 40960
    s_mov_b32 s73, 0
    s_mov_b32 s18, 0
    s_mov_b32 s19, 0
    s_mov_b32 s16, 0
    s_mov_b32 s17, 0
    s_lshl_b32 s13, s7, 5
    s_add_u32 s13, s13, s9
    s_mul_i32 s13, s13, 7
    s_lshr_b32 s40, s13, 4
    s_add_u32 s13, s13, s40
    s_add_u32 s13, s13, s6
    s_and_b32 s13, s13, 15
    v_mov_b32 v16, 0
    v_mov_b32 v17, 0
    v_mov_b32 v18, 0
    v_mov_b32 v19, 0
    v_mov_b32 v20, 0
    v_mov_b32 v21, 0
    v_mov_b32 v22, 0
    v_mov_b32 v23, 0
    v_mov_b32 v24, 0
    v_mov_b32 v25, 0
    v_mov_b32 v26, 0
    v_mov_b32 v27, 0
    v_mov_b32 v28, 0
    v_mov_b32 v29, 0
    v_mov_b32 v30, 0
    v_mov_b32 v31, 0
    v_mov_b32 v32, 0
    v_mov_b32 v33, 0
    v_mov_b32 v34, 0
    v_mov_b32 v35, 0
    v_mov_b32 v36, 0
    v_mov_b32 v37, 0
    v_mov_b32 v38, 0
    v_mov_b32 v39, 0
    v_mov_b32 v40, 0
    v_mov_b32 v41, 0
    v_mov_b32 v42, 0
    v_mov_b32 v43, 0
    v_mov_b32 v44, 0
    v_mov_b32 v45, 0
    v_mov_b32 v46, 0
    v_mov_b32 v47, 0
    v_mov_b32 v48, 0
    v_mov_b32 v49, 0
    v_mov_b32 v50, 0
    v_mov_b32 v51, 0
    v_mov_b32 v52, 0
    v_mov_b32 v53, 0
    v_mov_b32 v54, 0
    v_mov_b32 v55, 0
    v_mov_b32 v56, 0
    v_mov_b32 v57, 0
    v_mov_b32 v58, 0
    v_mov_b32 v59, 0
    v_mov_b32 v60, 0
    v_mov_b32 v61, 0
    v_mov_b32 v62, 0
    v_mov_b32 v63, 0
    v_mov_b32 v64, 0
    v_mov_b32 v65, 0
    v_mov_b32 v66, 0
    v_mov_b32 v67, 0
    v_mov_b32 v68, 0
    v_mov_b32 v69, 0
    v_mov_b32 v70, 0
    v_mov_b32 v71, 0
    v_mov_b32 v72, 0
    v_mov_b32 v73, 0
    v_mov_b32 v74, 0
    v_mov_b32 v75, 0
    v_mov_b32 v76, 0
    v_mov_b32 v77, 0
    v_mov_b32 v78, 0
    v_mov_b32 v79, 0
    v_mov_b32 v80, 0
    v_mov_b32 v81, 0
    v_mov_b32 v82, 0
    v_mov_b32 v83, 0
    v_mov_b32 v84, 0
    v_mov_b32 v85, 0
    v_mov_b32 v86, 0
    v_mov_b32 v87, 0
    v_mov_b32 v88, 0
    v_mov_b32 v89, 0
    v_mov_b32 v90, 0
    v_mov_b32 v91, 0
    v_mov_b32 v92, 0
    v_mov_b32 v93, 0
    v_mov_b32 v94, 0
    v_mov_b32 v95, 0
    v_mov_b32 v96, 0
    v_mov_b32 v97, 0
    v_mov_b32 v98, 0
    v_mov_b32 v99, 0
    v_mov_b32 v100, 0
    v_mov_b32 v101, 0
    v_mov_b32 v102, 0
    v_mov_b32 v103, 0
    v_mov_b32 v104, 0
    v_mov_b32 v105, 0
    v_mov_b32 v106, 0
    v_mov_b32 v107, 0
    v_mov_b32 v108, 0
    v_mov_b32 v109, 0
    v_mov_b32 v110, 0
    v_mov_b32 v111, 0
    v_accvgpr_write_b32 a80, 0
    v_accvgpr_write_b32 a81, 0
    v_accvgpr_write_b32 a82, 0
    v_accvgpr_write_b32 a83, 0
    v_accvgpr_write_b32 a84, 0
    v_accvgpr_write_b32 a85, 0
    v_accvgpr_write_b32 a86, 0
    v_accvgpr_write_b32 a87, 0
    v_accvgpr_write_b32 a88, 0
    v_accvgpr_write_b32 a89, 0
    v_accvgpr_write_b32 a90, 0
    v_accvgpr_write_b32 a91, 0
    v_accvgpr_write_b32 a92, 0
    v_accvgpr_write_b32 a93, 0
    v_accvgpr_write_b32 a94, 0
    v_accvgpr_write_b32 a95, 0
    s_and_b32 s40, s74, 1
    s_cmp_eq_u32 s40, 0
    s_cselect_b32 s44, s28, s32
    s_cselect_b32 s45, s29, s33
    s_mov_b32 s46, 131072
    s_mov_b32 s47, 0x20000
    s_cselect_b32 s78, 4, 3
    s_lshr_b32 s40, s74, 1
    s_add_u32 s78, s78, s40
    s_lshl_b32 s78, s78, 13
    v_lshlrev_b32 v126, 3, v0
    s_lshl_b32 s79, s3, 8
    s_add_u32 s79, s79, 65536
    s_waitcnt vmcnt(8) lgkmcnt(0)
    s_barrier
    s_cmp_eq_u32 s3, 0
    s_cbranch_scc0 L_noreg
    s_mul_i32 s40, s5, s5
    s_lshl_b32 s40, s40, 8
    s_lshl_b32 s41, s5, 3
    s_add_u32 s40, s40, s41
    s_add_u32 s40, s40, 1
    s_lshl_b32 s41, s11, 2
    s_mov_b64 exec, 1
    v_mov_b32 v11, s41
    v_mov_b32 v12, s40
    global_atomic_add v11, v12, s[62:63]
    s_mov_b64 exec, -1
L_noreg:
    ds_read_b128 a[32:35], v120 offset:0
    ds_read_b128 a[36:39], v120 offset:2048
    ds_read_b128 a[40:43], v120 offset:4096
    ds_read_b128 a[44:47], v121 offset:0
    ds_read_b128 a[48:51], v121 offset:2048
    ds_read_b128 a[52:55], v121 offset:4096
    ds_read_b64_tr_b16 a[0:1], v112 offset:0
    ds_read_b64_tr_b16 a[2:3], v112 offset:2048
    ds_read_b64_tr_b16 a[4:5], v113 offset:0
    ds_read_b64_tr_b16 a[6:7], v113 offset:2048
    ds_read_b64_tr_b16 a[8:9], v114 offset:0
    ds_read_b64_tr_b16 a[10:11], v114 offset:2048
    ds_read_b64_tr_b16 a[12:13], v115 offset:0
    ds_read_b64_tr_b16 a[14:15], v115 offset:2048
    ds_read_b64_tr_b16 a[16:17], v116 offset:0
    ds_read_b64_tr_b16 a[18:19], v116 offset:2048
    s_waitcnt lgkmcnt(10)
    s_mov_b32 s72, 0
    s_cmp_eq_u32 s4, 0
    s_cbranch_scc0 L_q_loop1
.p2align 6
L_q_loop0:
    s_waitcnt vmcnt(6)
    s_barrier
    s_waitcnt lgkmcnt(8)
    v_mfma_f32_16x16x32_bf16 v[16:19], a[0:3], a[32:35], v[16:19]
    ds_read_b64_tr_b16 a[20:21], v117 offset:0
    v_mfma_f32_16x16x32_bf16 v[20:23], a[0:3], a[36:39], v[20:23]
    ds_read_b64_tr_b16 a[22:23], v117 offset:2048
    s_add_u32 m0, s65, 49152
    v_mfma_f32_16x16x32_bf16 v[24:27], a[0:3], a[40:43], v[24:27]
    buffer_load_dwordx4 v124, s[24:27], s71 offen lds
    s_waitcnt lgkmcnt(8)
    v_mfma_f32_16x16x32_bf16 v[28:31], a[4:7], a[32:35], v[28:31]
    ds_read_b64_tr_b16 a[24:25], v118 offset:0
    v_mfma_f32_16x16x32_bf16 v[32:35], a[4:7], a[36:39], v[32:35]
    ds_read_b64_tr_b16 a[26:27], v118 offset:2048
    v_mfma_f32_16x16x32_bf16 v[36:39], a[4:7], a[40:43], v[36:39]
    s_waitcnt lgkmcnt(8)
    v_mfma_f32_16x16x32_bf16 v[40:43], a[8:11], a[32:35], v[40:43]
    ds_read_b64_tr_b16 a[28:29], v119 offset:0
    s_add_u32 m0, s65, 50176
    v_mfma_f32_16x16x32_bf16 v[44:47], a[8:11], a[36:39], v[44:47]
    ds_read_b64_tr_b16 a[30:31], v119 offset:2048
    buffer_load_dwordx4 v125, s[24:27], s71 offen lds
    v_mfma_f32_16x16x32_bf16 v[48:51], a[8:11], a[40:43], v[48:51]
    s_waitcnt lgkmcnt(8)
    v_mfma_f32_16x16x32_bf16 v[52:55], a[12:15], a[32:35], v[52:55]
    ds_read_b64_tr_b16 a[0:1], v112 offset:16384
    v_mfma_f32_16x16x32_bf16 v[56:59], a[12:15], a[36:39], v[56:59]
    ds_read_b64_tr_b16 a[2:3], v112 offset:18432
    v_mfma_f32_16x16x32_bf16 v[60:63], a[12:15], a[40:43], v[60:63]
    s_add_u32 m0, s64, 0
    s_add_u32 s40, s70, 0
    s_waitcnt lgkmcnt(8)
    v_mfma_f32_16x16x32_bf16 v[64:67], a[16:19], a[32:35], v[64:67]
    ds_read_b64_tr_b16 a[4:5], v113 offset:16384
    buffer_load_dwordx4 v122, s[20:23], s40 offen lds
    v_mfma_f32_16x16x32_bf16 v[68:71], a[16:19], a[36:39], v[68:71]
    ds_read_b64_tr_b16 a[6:7], v113 offset:18432
    v_mfma_f32_16x16x32_bf16 v[72:75], a[16:19], a[40:43], v[72:75]
    s_waitcnt lgkmcnt(8)
    v_mfma_f32_16x16x32_bf16 v[76:79], a[20:23], a[32:35], v[76:79]
    ds_read_b64_tr_b16 a[8:9], v114 offset:16384
    v_mfma_f32_16x16x32_bf16 v[80:83], a[20:23], a[36:39], v[80:83]
    ds_read_b64_tr_b16 a[10:11], v114 offset:18432
    s_add_u32 m0, s64, 1024
    s_add_u32 s40, s70, 10240
    v_mfma_f32_16x16x32_bf16 v[84:87], a[20:23], a[40:43], v[84:87]
    buffer_load_dwordx4 v123, s[20:23], s40 offen lds
    s_waitcnt lgkmcnt(8)
    v_mfma_f32_16x16x32_bf16 v[88:91], a[24:27], a[32:35], v[88:91]
    ds_read_b64_tr_b16 a[12:13], v115 offset:16384
    v_mfma_f32_16x16x32_bf16 v[92:95], a[24:27], a[36:39], v[92:95]
    ds_read_b64_tr_b16 a[14:15], v115 offset:18432
    v_mfma_f32_16x16x32_bf16 v[96:99], a[24:27], a[40:43], v[96:99]
    s_waitcnt lgkmcnt(8)
    v_mfma_f32_16x16x32_bf16 v[100:103], a[28:31], a[32:35], v[100:103]
    ds_read_b64_tr_b16 a[16:17], v116 offset:16384
    s_add_u32 s71, s71, 262144
    s_cmp_eq_u32 s71, 5242880
    s_cselect_b32 s71, 0, s71
    v_mfma_f32_16x16x32_bf16 v[104:107], a[28:31], a[36:39], v[104:107]
    ds_read_b64_tr_b16 a[18:19], v116 offset:18432
    v_mfma_f32_16x16x32_bf16 v[108:111], a[28:31], a[40:43], v[108:111]
    s_waitcnt vmcnt(5)
    s_barrier
    s_waitcnt lgkmcnt(8)
    v_mfma_f32_16x16x32_bf16 v[16:19], a[0:3], a[44:47], v[16:19]
    ds_read_b64_tr_b16 a[20:21], v117 offset:16384
    ds_read_b128 a[56:59], v120 offset:24576
    v_mfma_f32_16x16x32_bf16 v[20:23], a[0:3], a[48:51], v[20:23]
    ds_read_b64_tr_b16 a[22:23], v117 offset:18432
    ds_read_b128 a[60:63], v120 offset:26624
    s_add_u32 m0, s65, 0
    v_mfma_f32_16x16x32_bf16 v[24:27], a[0:3], a[52:55], v[24:27]
    ds_read_b128 a[64:67], v120 offset:28672
    buffer_load_dwordx4 v124, s[24:27], s71 offen lds
    s_waitcnt lgkmcnt(11)
    v_mfma_f32_16x16x32_bf16 v[28:31], a[4:7], a[44:47], v[28:31]
    ds_read_b64_tr_b16 a[24:25], v118 offset:16384
    ds_read_b128 a[68:71], v121 offset:24576
    v_mfma_f32_16x16x32_bf16 v[32:35], a[4:7], a[48:51], v[32:35]
    ds_read_b64_tr_b16 a[26:27], v118 offset:18432
    ds_read_b128 a[72:75], v121 offset:26624
    v_mfma_f32_16x16x32_bf16 v[36:39], a[4:7], a[52:55], v[36:39]
    ds_read_b128 a[76:79], v121 offset:28672
    s_waitcnt lgkmcnt(14)
    v_mfma_f32_16x16x32_bf16 v[40:43], a[8:11], a[44:47], v[40:43]
    ds_read_b64_tr_b16 a[28:29], v119 offset:16384
    s_add_u32 m0, s65, 1024
    v_mfma_f32_16x16x32_bf16 v[44:47], a[8:11], a[48:51], v[44:47]
    ds_read_b64_tr_b16 a[30:31], v119 offset:18432
    buffer_load_dwordx4 v125, s[24:27], s71 offen lds
    v_mfma_f32_16x16x32_bf16 v[48:51], a[8:11], a[52:55], v[48:51]
    s_waitcnt lgkmcnt(14)
    v_mfma_f32_16x16x32_bf16 v[52:55], a[12:15], a[44:47], v[52:55]
    ds_read_b64_tr_b16 a[0:1], v112 offset:32768
    v_mfma_f32_16x16x32_bf16 v[56:59], a[12:15], a[48:51], v[56:59]
    ds_read_b64_tr_b16 a[2:3], v112 offset:34816
    v_mfma_f32_16x16x32_bf16 v[60:63], a[12:15], a[52:55], v[60:63]
    s_add_u32 m0, s64, 2048
    s_add_u32 s40, s70, 20480
    s_waitcnt lgkmcnt(14)
    v_mfma_f32_16x16x32_bf16 v[64:67], a[16:19], a[44:47], v[64:67]
    ds_read_b64_tr_b16 a[4:5], v113 offset:32768
    buffer_load_dwordx4 v122, s[20:23], s40 offen lds
    v_mfma_f32_16x16x32_bf16 v[68:71], a[16:19], a[48:51], v[68:71]
    ds_read_b64_tr_b16 a[6:7], v113 offset:34816
    v_mfma_f32_16x16x32_bf16 v[72:75], a[16:19], a[52:55], v[72:75]
    s_waitcnt lgkmcnt(13)
    v_mfma_f32_16x16x32_bf16 v[76:79], a[20:23], a[44:47], v[76:79]
    ds_read_b64_tr_b16 a[8:9], v114 offset:32768
    v_mfma_f32_16x16x32_bf16 v[80:83], a[20:23], a[48:51], v[80:83]
    ds_read_b64_tr_b16 a[10:11], v114 offset:34816
    v_mfma_f32_16x16x32_bf16 v[84:87], a[20:23], a[52:55], v[84:87]
    s_waitcnt lgkmcnt(10)
    v_mfma_f32_16x16x32_bf16 v[88:91], a[24:27], a[44:47], v[88:91]
    ds_read_b64_tr_b16 a[12:13], v115 offset:32768
    v_mfma_f32_16x16x32_bf16 v[92:95], a[24:27], a[48:51], v[92:95]
    ds_read_b64_tr_b16 a[14:15], v115 offset:34816
    v_mfma_f32_16x16x32_bf16 v[96:99], a[24:27], a[52:55], v[96:99]
    s_waitcnt lgkmcnt(8)
    v_mfma_f32_16x16x32_bf16 v[100:103], a[28:31], a[44:47], v[100:103]
    ds_read_b64_tr_b16 a[16:17], v116 offset:32768
    s_add_u32 s71, s71, 262144
    s_cmp_eq_u32 s71, 5242880
    s_cselect_b32 s71, 0, s71
    s_add_u32 s70, s70, 128
    s_cmp_eq_u32 s70, 1280
    s_cselect_b32 s70, 0, s70
    v_mfma_f32_16x16x32_bf16 v[104:107], a[28:31], a[48:51], v[104:107]
    ds_read_b64_tr_b16 a[18:19], v116 offset:34816
    s_cmp_lg_u32 s72, 1
    s_cbranch_scc1 L_q_nok1_0
    s_add_u32 s14, s18, s13
    s_and_b32 s14, s14, 15
    s_lshl_b32 s14, s14, 13
    s_cmp_lt_u32 s18, 16
    s_cselect_b32 s14, s14, 2130706432
    s_add_u32 s18, s18, 1
    s_add_u32 m0, s76, s16
    s_nop 0
    buffer_load_dwordx4 v7, s[28:31], s14 offen nt lds
    s_add_u32 m0, s76, s16
    s_add_u32 m0, m0, 1024
    s_add_u32 s16, s16, 8192
    s_cmp_eq_u32 s16, 24576
    s_cselect_b32 s16, 0, s16
    buffer_load_dwordx4 v8, s[28:31], s14 offen nt lds
L_q_nok1_0:
    v_mfma_f32_16x16x32_bf16 v[108:111], a[28:31], a[52:55], v[108:111]
    s_waitcnt vmcnt(5)
    s_barrier
    s_waitcnt lgkmcnt(8)
    v_mfma_f32_16x16x32_bf16 v[16:19], a[0:3], a[56:59], v[16:19]
    ds_read_b64_tr_b16 a[20:21], v117 offset:32768
    v_mfma_f32_16x16x32_bf16 v[20:23], a[0:3], a[60:63], v[20:23]
    ds_read_b64_tr_b16 a[22:23], v117 offset:34816
    s_add_u32 m0, s65, 16384
    v_mfma_f32_16x16x32_bf16 v[24:27], a[0:3], a[64:67], v[24:27]
    buffer_load_dwordx4 v124, s[24:27], s71 offen lds
    s_waitcnt lgkmcnt(8)
    v_mfma_f32_16x16x32_bf16 v[28:31], a[4:7], a[56:59], v[28:31]
    ds_read_b64_tr_b16 a[24:25], v118 offset:32768
    v_mfma_f32_16x16x32_bf16 v[32:35], a[4:7], a[60:63], v[32:35]
    ds_read_b64_tr_b16 a[26:27], v118 offset:34816
    v_mfma_f32_16x16x32_bf16 v[36:39], a[4:7], a[64:67], v[36:39]
    s_waitcnt lgkmcnt(8)
    v_mfma_f32_16x16x32_bf16 v[40:43], a[8:11], a[56:59], v[40:43]
    ds_read_b64_tr_b16 a[28:29], v119 offset:32768
    s_add_u32 m0, s65, 17408
    v_mfma_f32_16x16x32_bf16 v[44:47], a[8:11], a[60:63], v[44:47]
    ds_read_b64_tr_b16 a[30:31], v119 offset:34816
    buffer_load_dwordx4 v125, s[24:27], s71 offen lds
    v_mfma_f32_16x16x32_bf16 v[48:51], a[8:11], a[64:67], v[48:51]
    s_waitcnt lgkmcnt(8)
    v_mfma_f32_16x16x32_bf16 v[52:55], a[12:15], a[56:59], v[52:55]
    ds_read_b64_tr_b16 a[0:1], v112 offset:49152
    v_mfma_f32_16x16x32_bf16 v[56:59], a[12:15], a[60:63], v[56:59]
    ds_read_b64_tr_b16 a[2:3], v112 offset:51200
    v_mfma_f32_16x16x32_bf16 v[60:63], a[12:15], a[64:67], v[60:63]
    s_add_u32 m0, s64, 24576
    s_add_u32 s40, s70, 0
    s_waitcnt lgkmcnt(8)
    v_mfma_f32_16x16x32_bf16 v[64:67], a[16:19], a[56:59], v[64:67]
    ds_read_b64_tr_b16 a[4:5], v113 offset:49152
    buffer_load_dwordx4 v122, s[20:23], s40 offen lds
    v_mfma_f32_16x16x32_bf16 v[68:71], a[16:19], a[60:63], v[68:71]
    ds_read_b64_tr_b16 a[6:7], v113 offset:51200
    v_mfma_f32_16x16x32_bf16 v[72:75], a[16:19], a[64:67], v[72:75]
    s_waitcnt lgkmcnt(8)
    v_mfma_f32_16x16x32_bf16 v[76:79], a[20:23], a[56:59], v[76:79]
    ds_read_b64_tr_b16 a[8:9], v114 offset:49152
    v_mfma_f32_16x16x32_bf16 v[80:83], a[20:23], a[60:63], v[80:83]
    ds_read_b64_tr_b16 a[10:11], v114 offset:51200
    s_add_u32 m0, s64, 25600
    s_add_u32 s40, s70, 10240
    v_mfma_f32_16x16x32_bf16 v[84:87], a[20:23], a[64:67], v[84:87]
    buffer_load_dwordx4 v123, s[20:23], s40 offen lds
    s_waitcnt lgkmcnt(8)
    v_mfma_f32_16x16x32_bf16 v[88:91], a[24:27], a[56:59], v[88:91]
    ds_read_b64_tr_b16 a[12:13], v115 offset:49152
    v_mfma_f32_16x16x32_bf16 v[92:95], a[24:27], a[60:63], v[92:95]
    ds_read_b64_tr_b16 a[14:15], v115 offset:51200
    v_mfma_f32_16x16x32_bf16 v[96:99], a[24:27], a[64:67], v[96:99]
    s_waitcnt lgkmcnt(8)
    v_mfma_f32_16x16x32_bf16 v[100:103], a[28:31], a[56:59], v[100:103]
    ds_read_b64_tr_b16 a[16:17], v116 offset:49152
    s_add_u32 s71, s71, 262144
    s_cmp_eq_u32 s71, 5242880
    s_cselect_b32 s71, 0, s71
    v_mfma_f32_16x16x32_bf16 v[104:107], a[28:31], a[60:63], v[104:107]
    ds_read_b64_tr_b16 a[18:19], v116 offset:51200
    v_mfma_f32_16x16x32_bf16 v[108:111], a[28:31], a[64:67], v[108:111]
    s_waitcnt vmcnt(4)
    s_barrier
    s_waitcnt lgkmcnt(8)
    v_mfma_f32_16x16x32_bf16 v[16:19], a[0:3], a[68:71], v[16:19]
    ds_read_b64_tr_b16 a[20:21], v117 offset:49152
    ds_read_b128 a[32:35], v120 offset:0
    v_mfma_f32_16x16x32_bf16 v[20:23], a[0:3], a[72:75], v[20:23]
    ds_read_b64_tr_b16 a[22:23], v117 offset:51200
    ds_read_b128 a[36:39], v120 offset:2048
    s_add_u32 m0, s65, 32768
    v_mfma_f32_16x16x32_bf16 v[24:27], a[0:3], a[76:79], v[24:27]
    ds_read_b128 a[40:43], v120 offset:4096
    buffer_load_dwordx4 v124, s[24:27], s71 offen lds
    s_waitcnt lgkmcnt(11)
    v_mfma_f32_16x16x32_bf16 v[28:31], a[4:7], a[68:71], v[28:31]
    ds_read_b64_tr_b16 a[24:25], v118 offset:49152
    ds_read_b128 a[44:47], v121 offset:0
    v_mfma_f32_16x16x32_bf16 v[32:35], a[4:7], a[72:75], v[32:35]
    ds_read_b64_tr_b16 a[26:27], v118 offset:51200
    ds_read_b128 a[48:51], v121 offset:2048
    v_mfma_f32_16x16x32_bf16 v[36:39], a[4:7], a[76:79], v[36:39]
    ds_read_b128 a[52:55], v121 offset:4096
    s_waitcnt lgkmcnt(14)
    v_mfma_f32_16x16x32_bf16 v[40:43], a[8:11], a[68:71], v[40:43]
    ds_read_b64_tr_b16 a[28:29], v119 offset:49152
    s_add_u32 m0, s65, 33792
    v_mfma_f32_16x16x32_bf16 v[44:47], a[8:11], a[72:75], v[44:47]
    ds_read_b64_tr_b16 a[30:31], v119 offset:51200
    buffer_load_dwordx4 v125, s[24:27], s71 offen lds
    v_mfma_f32_16x16x32_bf16 v[48:51], a[8:11], a[76:79], v[48:51]
    s_waitcnt lgkmcnt(14)
    v_mfma_f32_16x16x32_bf16 v[52:55], a[12:15], a[68:71], v[52:55]
    ds_read_b64_tr_b16 a[0:1], v112 offset:0
    v_mfma_f32_16x16x32_bf16 v[56:59], a[12:15], a[72:75], v[56:59]
    ds_read_b64_tr_b16 a[2:3], v112 offset:2048
    v_mfma_f32_16x16x32_bf16 v[60:63], a[12:15], a[76:79], v[60:63]
    s_add_u32 m0, s64, 26624
    s_add_u32 s40, s70, 20480
    s_waitcnt lgkmcnt(14)
    v_mfma_f32_16x16x32_bf16 v[64:67], a[16:19], a[68:71], v[64:67]
    ds_read_b64_tr_b16 a[4:5], v113 offset:0
    buffer_load_dwordx4 v122, s[20:23], s40 offen lds
    v_mfma_f32_16x16x32_bf16 v[68:71], a[16:19], a[72:75], v[68:71]
    ds_read_b64_tr_b16 a[6:7], v113 offset:2048
    v_mfma_f32_16x16x32_bf16 v[72:75], a[16:19], a[76:79], v[72:75]
    s_waitcnt lgkmcnt(13)
    v_mfma_f32_16x16x32_bf16 v[76:79], a[20:23], a[68:71], v[76:79]
    ds_read_b64_tr_b16 a[8:9], v114 offset:0
    v_mfma_f32_16x16x32_bf16 v[80:83], a[20:23], a[72:75], v[80:83]
    ds_read_b64_tr_b16 a[10:11], v114 offset:2048
    v_mfma_f32_16x16x32_bf16 v[84:87], a[20:23], a[76:79], v[84:87]
    s_waitcnt lgkmcnt(10)
    v_mfma_f32_16x16x32_bf16 v[88:91], a[24:27], a[68:71], v[88:91]
    ds_read_b64_tr_b16 a[12:13], v115 offset:0
    v_mfma_f32_16x16x32_bf16 v[92:95], a[24:27], a[72:75], v[92:95]
    ds_read_b64_tr_b16 a[14:15], v115 offset:2048
    v_mfma_f32_16x16x32_bf16 v[96:99], a[24:27], a[76:79], v[96:99]
    s_cmp_ge_u32 s72, 4
    s_cselect_b32 s40, s78, 2130706432
    s_mov_b32 m0, s79
    s_cselect_b32 s41, 16384, 0
    buffer_load_dword v126, s[44:47], s40 offen lds
    s_add_u32 s78, s78, s41
    s_waitcnt lgkmcnt(8)
    v_mfma_f32_16x16x32_bf16 v[100:103], a[28:31], a[68:71], v[100:103]
    ds_read_b64_tr_b16 a[16:17], v116 offset:0
    s_add_u32 s71, s71, 262144
    s_cmp_eq_u32 s71, 5242880
    s_cselect_b32 s71, 0, s71
    s_add_u32 s70, s70, 128
    s_cmp_eq_u32 s70, 1280
    s_cselect_b32 s70, 0, s70
    v_mfma_f32_16x16x32_bf16 v[104:107], a[28:31], a[72:75], v[104:107]
    ds_read_b64_tr_b16 a[18:19], v116 offset:2048
    s_cmp_lg_u32 s72, 1
    s_cbranch_scc1 L_q_nok3_0
    s_add_u32 s14, s18, s13
    s_and_b32 s14, s14, 15
    s_lshl_b32 s14, s14, 13
    s_cmp_lt_u32 s18, 16
    s_cselect_b32 s14, s14, 2130706432
    s_add_u32 s18, s18, 1
    s_add_u32 m0, s76, s16
    s_nop 0
    buffer_load_dwordx4 v7, s[28:31], s14 offen nt lds
    s_add_u32 m0, s76, s16
    s_add_u32 m0, m0, 1024
    s_add_u32 s16, s16, 8192
    s_cmp_eq_u32 s16, 24576
    s_cselect_b32 s16, 0, s16
    buffer_load_dwordx4 v8, s[28:31], s14 offen nt lds
L_q_nok3_0:
    v_mfma_f32_16x16x32_bf16 v[108:111], a[28:31], a[76:79], v[108:111]
    s_add_u32 s72, s72, 1
    s_cmp_lt_u32 s72, 4
    s_cbranch_scc1 L_q_loop0
    s_branch L_q_tail
.p2align 6
L_q_loop1:
    s_waitcnt vmcnt(6)
    s_barrier
    s_waitcnt lgkmcnt(8)
    v_mfma_f32_16x16x32_bf16 v[16:19], a[0:3], a[32:35], v[16:19]
    ds_read_b64_tr_b16 a[20:21], v117 offset:0
    v_mfma_f32_16x16x32_bf16 v[20:23], a[0:3], a[36:39], v[20:23]
    ds_read_b64_tr_b16 a[22:23], v117 offset:2048
    v_mfma_f32_16x16x32_bf16 v[24:27], a[0:3], a[40:43], v[24:27]
    s_waitcnt lgkmcnt(8)
    v_mfma_f32_16x16x32_bf16 v[28:31], a[4:7], a[32:35], v[28:31]
    ds_read_b64_tr_b16 a[24:25], v118 offset:0
    s_add_u32 m0, s65, 49152
    v_mfma_f32_16x16x32_bf16 v[32:35], a[4:7], a[36:39], v[32:35]
    ds_read_b64_tr_b16 a[26:27], v118 offset:2048
    buffer_load_dwordx4 v124, s[24:27], s71 offen lds
    v_mfma_f32_16x16x32_bf16 v[36:39], a[4:7], a[40:43], v[36:39]
    s_waitcnt lgkmcnt(8)
    v_mfma_f32_16x16x32_bf16 v[40:43], a[8:11], a[32:35], v[40:43]
    ds_read_b64_tr_b16 a[28:29], v119 offset:0
    v_mfma_f32_16x16x32_bf16 v[44:47], a[8:11], a[36:39], v[44:47]
    ds_read_b64_tr_b16 a[30:31], v119 offset:2048
    v_mfma_f32_16x16x32_bf16 v[48:51], a[8:11], a[40:43], v[48:51]
    s_add_u32 m0, s65, 50176
    s_waitcnt lgkmcnt(8)
    v_mfma_f32_16x16x32_bf16 v[52:55], a[12:15], a[32:35], v[52:55]
    ds_read_b64_tr_b16 a[0:1], v112 offset:16384
    buffer_load_dwordx4 v125, s[24:27], s71 offen lds
    v_mfma_f32_16x16x32_bf16 v[56:59], a[12:15], a[36:39], v[56:59]
    ds_read_b64_tr_b16 a[2:3], v112 offset:18432
    v_mfma_f32_16x16x32_bf16 v[60:63], a[12:15], a[40:43], v[60:63]
    s_waitcnt lgkmcnt(8)
    v_mfma_f32_16x16x32_bf16 v[64:67], a[16:19], a[32:35], v[64:67]
    ds_read_b64_tr_b16 a[4:5], v113 offset:16384
    v_mfma_f32_16x16x32_bf16 v[68:71], a[16:19], a[36:39], v[68:71]
    ds_read_b64_tr_b16 a[6:7], v113 offset:18432
    s_add_u32 m0, s64, 0
    s_add_u32 s40, s70, 0
    v_mfma_f32_16x16x32_bf16 v[72:75], a[16:19], a[40:43], v[72:75]
    buffer_load_dwordx4 v122, s[20:23], s40 offen lds
    s_waitcnt lgkmcnt(8)
    v_mfma_f32_16x16x32_bf16 v[76:79], a[20:23], a[32:35], v[76:79]
    ds_read_b64_tr_b16 a[8:9], v114 offset:16384
    v_mfma_f32_16x16x32_bf16 v[80:83], a[20:23], a[36:39], v[80:83]
    ds_read_b64_tr_b16 a[10:11], v114 offset:18432
    v_mfma_f32_16x16x32_bf16 v[84:87], a[20:23], a[40:43], v[84:87]
    s_waitcnt lgkmcnt(8)
    v_mfma_f32_16x16x32_bf16 v[88:91], a[24:27], a[32:35], v[88:91]
    ds_read_b64_tr_b16 a[12:13], v115 offset:16384
    s_add_u32 m0, s64, 1024
    s_add_u32 s40, s70, 10240
    v_mfma_f32_16x16x32_bf16 v[92:95], a[24:27], a[36:39], v[92:95]
    ds_read_b64_tr_b16 a[14:15], v115 offset:18432
    buffer_load_dwordx4 v123, s[20:23], s40 offen lds
    v_mfma_f32_16x16x32_bf16 v[96:99], a[24:27], a[40:43], v[96:99]
    s_waitcnt lgkmcnt(8)
    v_mfma_f32_16x16x32_bf16 v[100:103], a[28:31], a[32:35], v[100:103]
    ds_read_b64_tr_b16 a[16:17], v116 offset:16384
    s_add_u32 s71, s71, 262144
    s_cmp_eq_u32 s71, 5242880
    s_cselect_b32 s71, 0, s71
    v_mfma_f32_16x16x32_bf16 v[104:107], a[28:31], a[36:39], v[104:107]
    ds_read_b64_tr_b16 a[18:19], v116 offset:18432
    v_mfma_f32_16x16x32_bf16 v[108:111], a[28:31], a[40:43], v[108:111]
    s_waitcnt vmcnt(5)
    s_barrier
    s_waitcnt lgkmcnt(8)
    v_mfma_f32_16x16x32_bf16 v[16:19], a[0:3], a[44:47], v[16:19]
    ds_read_b64_tr_b16 a[20:21], v117 offset:16384
    ds_read_b128 a[56:59], v120 offset:24576
    v_mfma_f32_16x16x32_bf16 v[20:23], a[0:3], a[48:51], v[20:23]
    ds_read_b64_tr_b16 a[22:23], v117 offset:18432
    ds_read_b128 a[60:63], v120 offset:26624
    v_mfma_f32_16x16x32_bf16 v[24:27], a[0:3], a[52:55], v[24:27]
    ds_read_b128 a[64:67], v120 offset:28672
    s_waitcnt lgkmcnt(11)
    v_mfma_f32_16x16x32_bf16 v[28:31], a[4:7], a[44:47], v[28:31]
    ds_read_b64_tr_b16 a[24:25], v118 offset:16384
    ds_read_b128 a[68:71], v121 offset:24576
    s_add_u32 m0, s65, 0
    v_mfma_f32_16x16x32_bf16 v[32:35], a[4:7], a[48:51], v[32:35]
    ds_read_b64_tr_b16 a[26:27], v118 offset:18432
    ds_read_b128 a[72:75], v121 offset:26624
    buffer_load_dwordx4 v124, s[24:27], s71 offen lds
    v_mfma_f32_16x16x32_bf16 v[36:39], a[4:7], a[52:55], v[36:39]
    ds_read_b128 a[76:79], v121 offset:28672
    s_waitcnt lgkmcnt(14)
    v_mfma_f32_16x16x32_bf16 v[40:43], a[8:11], a[44:47], v[40:43]
    ds_read_b64_tr_b16 a[28:29], v119 offset:16384
    v_mfma_f32_16x16x32_bf16 v[44:47], a[8:11], a[48:51], v[44:47]
    ds_read_b64_tr_b16 a[30:31], v119 offset:18432
    v_mfma_f32_16x16x32_bf16 v[48:51], a[8:11], a[52:55], v[48:51]
    s_add_u32 m0, s65, 1024
    s_waitcnt lgkmcnt(14)
    v_mfma_f32_16x16x32_bf16 v[52:55], a[12:15], a[44:47], v[52:55]
    ds_read_b64_tr_b16 a[0:1], v112 offset:32768
    buffer_load_dwordx4 v125, s[24:27], s71 offen lds
    v_mfma_f32_16x16x32_bf16 v[56:59], a[12:15], a[48:51], v[56:59]
    ds_read_b64_tr_b16 a[2:3], v112 offset:34816
    v_mfma_f32_16x16x32_bf16 v[60:63], a[12:15], a[52:55], v[60:63]
    s_waitcnt lgkmcnt(14)
    v_mfma_f32_16x16x32_bf16 v[64:67], a[16:19], a[44:47], v[64:67]
    ds_read_b64_tr_b16 a[4:5], v113 offset:32768
    v_mfma_f32_16x16x32_bf16 v[68:71], a[16:19], a[48:51], v[68:71]
    ds_read_b64_tr_b16 a[6:7], v113 offset:34816
    s_add_u32 m0, s64, 2048
    s_add_u32 s40, s70, 20480
    v_mfma_f32_16x16x32_bf16 v[72:75], a[16:19], a[52:55], v[72:75]
    buffer_load_dwordx4 v122, s[20:23], s40 offen lds
    s_waitcnt lgkmcnt(13)
    v_mfma_f32_16x16x32_bf16 v[76:79], a[20:23], a[44:47], v[76:79]
    ds_read_b64_tr_b16 a[8:9], v114 offset:32768
    v_mfma_f32_16x16x32_bf16 v[80:83], a[20:23], a[48:51], v[80:83]
    ds_read_b64_tr_b16 a[10:11], v114 offset:34816
    v_mfma_f32_16x16x32_bf16 v[84:87], a[20:23], a[52:55], v[84:87]
    s_waitcnt lgkmcnt(10)
    v_mfma_f32_16x16x32_bf16 v[88:91], a[24:27], a[44:47], v[88:91]
    ds_read_b64_tr_b16 a[12:13], v115 offset:32768
    v_mfma_f32_16x16x32_bf16 v[92:95], a[24:27], a[48:51], v[92:95]
    ds_read_b64_tr_b16 a[14:15], v115 offset:34816
    v_mfma_f32_16x16x32_bf16 v[96:99], a[24:27], a[52:55], v[96:99]
    s_waitcnt lgkmcnt(8)
    v_mfma_f32_16x16x32_bf16 v[100:103], a[28:31], a[44:47], v[100:103]
    ds_read_b64_tr_b16 a[16:17], v116 offset:32768
    s_add_u32 s71, s71, 262144
    s_cmp_eq_u32 s71, 5242880
    s_cselect_b32 s71, 0, s71
    s_add_u32 s70, s70, 128
    s_cmp_eq_u32 s70, 1280
    s_cselect_b32 s70, 0, s70
    v_mfma_f32_16x16x32_bf16 v[104:107], a[28:31], a[48:51], v[104:107]
    ds_read_b64_tr_b16 a[18:19], v116 offset:34816
    s_cmp_lg_u32 s72, 1
    s_cbranch_scc1 L_q_nok1_1
    s_add_u32 s14, s18, s13
    s_and_b32 s14, s14, 15
    s_lshl_b32 s14, s14, 13
    s_cmp_lt_u32 s18, 16
    s_cselect_b32 s14, s14, 2130706432
    s_add_u32 s18, s18, 1
    s_add_u32 m0, s76, s16
    s_nop 0
    buffer_load_dwordx4 v7, s[28:31], s14 offen nt lds
    s_add_u32 m0, s76, s16
    s_add_u32 m0, m0, 1024
    s_add_u32 s16, s16, 8192
    s_cmp_eq_u32 s16, 24576
    s_cselect_b32 s16, 0, s16
    buffer_load_dwordx4 v8, s[28:31], s14 offen nt lds
L_q_nok1_1:
    v_mfma_f32_16x16x32_bf16 v[108:111], a[28:31], a[52:55], v[108:111]
    s_waitcnt vmcnt(5)
    s_barrier
    s_waitcnt lgkmcnt(8)
    v_mfma_f32_16x16x32_bf16 v[16:19], a[0:3], a[56:59], v[16:19]
    ds_read_b64_tr_b16 a[20:21], v117 offset:32768
    v_mfma_f32_16x16x32_bf16 v[20:23], a[0:3], a[60:63], v[20:23]
    ds_read_b64_tr_b16 a[22:23], v117 offset:34816
    v_mfma_f32_16x16x32_bf16 v[24:27], a[0:3], a[64:67], v[24:27]
    s_waitcnt lgkmcnt(8)
    v_mfma_f32_16x16x32_bf16 v[28:31], a[4:7], a[56:59], v[28:31]
    ds_read_b64_tr_b16 a[24:25], v118 offset:32768
    s_add_u32 m0, s65, 16384
    v_mfma_f32_16x16x32_bf16 v[32:35], a[4:7], a[60:63], v[32:35]
    ds_read_b64_tr_b16 a[26:27], v118 offset:34816
    buffer_load_dwordx4 v124, s[24:27], s71 offen lds
    v_mfma_f32_16x16x32_bf16 v[36:39], a[4:7], a[64:67], v[36:39]
    s_waitcnt lgkmcnt(8)
    v_mfma_f32_16x16x32_bf16 v[40:43], a[8:11], a[56:59], v[40:43]
    ds_read_b64_tr_b16 a[28:29], v119 offset:32768
    v_mfma_f32_16x16x32_bf16 v[44:47], a[8:11], a[60:63], v[44:47]
    ds_read_b64_tr_b16 a[30:31], v119 offset:34816
    v_mfma_f32_16x16x32_bf16 v[48:51], a[8:11], a[64:67], v[48:51]
    s_add_u32 m0, s65, 17408
    s_waitcnt lgkmcnt(8)
    v_mfma_f32_16x16x32_bf16 v[52:55], a[12:15], a[56:59], v[52:55]
    ds_read_b64_tr_b16 a[0:1], v112 offset:49152
    buffer_load_dwordx4 v125, s[24:27], s71 offen lds
    v_mfma_f32_16x16x32_bf16 v[56:59], a[12:15], a[60:63], v[56:59]
    ds_read_b64_tr_b16 a[2:3], v112 offset:51200
    v_mfma_f32_16x16x32_bf16 v[60:63], a[12:15], a[64:67], v[60:63]
    s_waitcnt lgkmcnt(8)
    v_mfma_f32_16x16x32_bf16 v[64:67], a[16:19], a[56:59], v[64:67]
    ds_read_b64_tr_b16 a[4:5], v113 offset:49152
    v_mfma_f32_16x16x32_bf16 v[68:71], a[16:19], a[60:63], v[68:71]
    ds_read_b64_tr_b16 a[6:7], v113 offset:51200
    s_add_u32 m0, s64, 24576
    s_add_u32 s40, s70, 0
    v_mfma_f32_16x16x32_bf16 v[72:75], a[16:19], a[64:67], v[72:75]
    buffer_load_dwordx4 v122, s[20:23], s40 offen lds
    s_waitcnt lgkmcnt(8)
    v_mfma_f32_16x16x32_bf16 v[76:79], a[20:23], a[56:59], v[76:79]
    ds_read_b64_tr_b16 a[8:9], v114 offset:49152
    v_mfma_f32_16x16x32_bf16 v[80:83], a[20:23], a[60:63], v[80:83]
    ds_read_b64_tr_b16 a[10:11], v114 offset:51200
    v_mfma_f32_16x16x32_bf16 v[84:87], a[20:23], a[64:67], v[84:87]
    s_waitcnt lgkmcnt(8)
    v_mfma_f32_16x16x32_bf16 v[88:91], a[24:27], a[56:59], v[88:91]
    ds_read_b64_tr_b16 a[12:13], v115 offset:49152
    s_add_u32 m0, s64, 25600
    s_add_u32 s40, s70, 10240
    v_mfma_f32_16x16x32_bf16 v[92:95], a[24:27], a[60:63], v[92:95]
    ds_read_b64_tr_b16 a[14:15], v115 offset:51200
    buffer_load_dwordx4 v123, s[20:23], s40 offen lds
    v_mfma_f32_16x16x32_bf16 v[96:99], a[24:27], a[64:67], v[96:99]
    s_waitcnt lgkmcnt(8)
    v_mfma_f32_16x16x32_bf16 v[100:103], a[28:31], a[56:59], v[100:103]
    ds_read_b64_tr_b16 a[16:17], v116 offset:49152
    s_add_u32 s71, s71, 262144
    s_cmp_eq_u32 s71, 5242880
    s_cselect_b32 s71, 0, s71
    v_mfma_f32_16x16x32_bf16 v[104:107], a[28:31], a[60:63], v[104:107]
    ds_read_b64_tr_b16 a[18:19], v116 offset:51200
    v_mfma_f32_16x16x32_bf16 v[108:111], a[28:31], a[64:67], v[108:111]
    s_waitcnt vmcnt(4)
    s_barrier
    s_waitcnt lgkmcnt(8)
    v_mfma_f32_16x16x32_bf16 v[16:19], a[0:3], a[68:71], v[16:19]
    ds_read_b64_tr_b16 a[20:21], v117 offset:49152
    ds_read_b128 a[32:35], v120 offset:0
    v_mfma_f32_16x16x32_bf16 v[20:23], a[0:3], a[72:75], v[20:23]
    ds_read_b64_tr_b16 a[22:23], v117 offset:51200
    ds_read_b128 a[36:39], v120 offset:2048
    v_mfma_f32_16x16x32_bf16 v[24:27], a[0:3], a[76:79], v[24:27]
    ds_read_b128 a[40:43], v120 offset:4096
    s_waitcnt lgkmcnt(11)
    v_mfma_f32_16x16x32_bf16 v[28:31], a[4:7], a[68:71], v[28:31]
    ds_read_b64_tr_b16 a[24:25], v118 offset:49152
    ds_read_b128 a[44:47], v121 offset:0
    s_add_u32 m0, s65, 32768
    v_mfma_f32_16x16x32_bf16 v[32:35], a[4:7], a[72:75], v[32:35]
    ds_read_b64_tr_b16 a[26:27], v118 offset:51200
    ds_read_b128 a[48:51], v121 offset:2048
    buffer_load_dwordx4 v124, s[24:27], s71 offen lds
    v_mfma_f32_16x16x32_bf16 v[36:39], a[4:7], a[76:79], v[36:39]
    ds_read_b128 a[52:55], v121 offset:4096
    s_waitcnt lgkmcnt(14)
    v_mfma_f32_16x16x32_bf16 v[40:43], a[8:11], a[68:71], v[40:43]
    ds_read_b64_tr_b16 a[28:29], v119 offset:49152
    v_mfma_f32_16x16x32_bf16 v[44:47], a[8:11], a[72:75], v[44:47]
    ds_read_b64_tr_b16 a[30:31], v119 offset:51200
    v_mfma_f32_16x16x32_bf16 v[48:51], a[8:11], a[76:79], v[48:51]
    s_add_u32 m0, s65, 33792
    s_waitcnt lgkmcnt(14)
    v_mfma_f32_16x16x32_bf16 v[52:55], a[12:15], a[68:71], v[52:55]
    ds_read_b64_tr_b16 a[0:1], v112 offset:0
    buffer_load_dwordx4 v125, s[24:27], s71 offen lds
    v_mfma_f32_16x16x32_bf16 v[56:59], a[12:15], a[72:75], v[56:59]
    ds_read_b64_tr_b16 a[2:3], v112 offset:2048
    v_mfma_f32_16x16x32_bf16 v[60:63], a[12:15], a[76:79], v[60:63]
    s_waitcnt lgkmcnt(14)
    v_mfma_f32_16x16x32_bf16 v[64:67], a[16:19], a[68:71], v[64:67]
    ds_read_b64_tr_b16 a[4:5], v113 offset:0
    v_mfma_f32_16x16x32_bf16 v[68:71], a[16:19], a[72:75], v[68:71]
    ds_read_b64_tr_b16 a[6:7], v113 offset:2048
    s_add_u32 m0, s64, 26624
    s_add_u32 s40, s70, 20480
    v_mfma_f32_16x16x32_bf16 v[72:75], a[16:19], a[76:79], v[72:75]
    buffer_load_dwordx4 v122, s[20:23], s40 offen lds
    s_waitcnt lgkmcnt(13)
    v_mfma_f32_16x16x32_bf16 v[76:79], a[20:23], a[68:71], v[76:79]
    ds_read_b64_tr_b16 a[8:9], v114 offset:0
    v_mfma_f32_16x16x32_bf16 v[80:83], a[20:23], a[72:75], v[80:83]
    ds_read_b64_tr_b16 a[10:11], v114 offset:2048
    v_mfma_f32_16x16x32_bf16 v[84:87], a[20:23], a[76:79], v[84:87]
    s_waitcnt lgkmcnt(10)
    v_mfma_f32_16x16x32_bf16 v[88:91], a[24:27], a[68:71], v[88:91]
    ds_read_b64_tr_b16 a[12:13], v115 offset:0
    v_mfma_f32_16x16x32_bf16 v[92:95], a[24:27], a[72:75], v[92:95]
    ds_read_b64_tr_b16 a[14:15], v115 offset:2048
    v_mfma_f32_16x16x32_bf16 v[96:99], a[24:27], a[76:79], v[96:99]
    s_cmp_ge_u32 s72, 4
    s_cselect_b32 s40, s78, 2130706432
    s_mov_b32 m0, s79
    s_cselect_b32 s41, 16384, 0
    buffer_load_dword v126, s[44:47], s40 offen lds
    s_add_u32 s78, s78, s41
    s_waitcnt lgkmcnt(8)
    v_mfma_f32_16x16x32_bf16 v[100:103], a[28:31], a[68:71], v[100:103]
    ds_read_b64_tr_b16 a[16:17], v116 offset:0
    s_add_u32 s71, s71, 262144
    s_cmp_eq_u32 s71, 5242880
    s_cselect_b32 s71, 0, s71
    s_add_u32 s70, s70, 128
    s_cmp_eq_u32 s70, 1280
    s_cselect_b32 s70, 0, s70
    v_mfma_f32_16x16x32_bf16 v[104:107], a[28:31], a[72:75], v[104:107]
    ds_read_b64_tr_b16 a[18:19], v116 offset:2048
    s_cmp_lg_u32 s72, 1
    s_cbranch_scc1 L_q_nok3_1
    s_add_u32 s14, s18, s13
    s_and_b32 s14, s14, 15
    s_lshl_b32 s14, s14, 13
    s_cmp_lt_u32 s18, 16
    s_cselect_b32 s14, s14, 2130706432
    s_add_u32 s18, s18, 1
    s_add_u32 m0, s76, s16
    s_nop 0
    buffer_load_dwordx4 v7, s[28:31], s14 offen nt lds
    s_add_u32 m0, s76, s16
    s_add_u32 m0, m0, 1024
    s_add_u32 s16, s16, 8192
    s_cmp_eq_u32 s16, 24576
    s_cselect_b32 s16, 0, s16
    buffer_load_dwordx4 v8, s[28:31], s14 offen nt lds
L_q_nok3_1:
    v_mfma_f32_16x16x32_bf16 v[108:111], a[28:31], a[76:79], v[108:111]
    s_add_u32 s72, s72, 1
    s_cmp_lt_u32 s72, 4
    s_cbranch_scc1 L_q_loop1
L_q_tail:
    s_cmp_eq_u32 s6, 0
    s_cselect_b64 s[58:59], s[52:53], s[54:55]
    s_lshr_b32 s40, s2, 3
    s_lshl_b32 s40, s40, 3
    s_add_u32 s40, s40, s3
    s_mul_i32 s40, s40, 5120
    s_mul_i32 s41, s8, 1310720
    s_add_u32 s40, s40, s41
    s_add_u32 s48, s58, s40
    s_addc_u32 s49, s59, 0
    s_mov_b32 s50, 5120
    s_mov_b32 s51, 0x20000
    s_waitcnt vmcnt(6)
    s_barrier
    s_waitcnt lgkmcnt(8)
    v_mfma_f32_16x16x32_bf16 v[16:19], a[0:3], a[32:35], v[16:19]
    ds_read_b64_tr_b16 a[20:21], v117 offset:0
    v_mfma_f32_16x16x32_bf16 v[20:23], a[0:3], a[36:39], v[20:23]
    ds_read_b64_tr_b16 a[22:23], v117 offset:2048
    s_add_u32 m0, s65, 49152
    v_mfma_f32_16x16x32_bf16 v[24:27], a[0:3], a[40:43], v[24:27]
    buffer_load_dwordx4 v124, s[24:27], s71 offen lds
    s_waitcnt lgkmcnt(8)
    v_mfma_f32_16x16x32_bf16 v[28:31], a[4:7], a[32:35], v[28:31]
    ds_read_b64_tr_b16 a[24:25], v118 offset:0
    v_mfma_f32_16x16x32_bf16 v[32:35], a[4:7], a[36:39], v[32:35]
    ds_read_b64_tr_b16 a[26:27], v118 offset:2048
    v_mfma_f32_16x16x32_bf16 v[36:39], a[4:7], a[40:43], v[36:39]
    s_add_u32 m0, s65, 50176
    s_waitcnt lgkmcnt(8)
    v_mfma_f32_16x16x32_bf16 v[40:43], a[8:11], a[32:35], v[40:43]
    ds_read_b64_tr_b16 a[28:29], v119 offset:0
    buffer_load_dwordx4 v125, s[24:27], s71 offen lds
    v_mfma_f32_16x16x32_bf16 v[44:47], a[8:11], a[36:39], v[44:47]
    ds_read_b64_tr_b16 a[30:31], v119 offset:2048
    v_mfma_f32_16x16x32_bf16 v[48:51], a[8:11], a[40:43], v[48:51]
    s_waitcnt lgkmcnt(8)
    v_mfma_f32_16x16x32_bf16 v[52:55], a[12:15], a[32:35], v[52:55]
    ds_read_b64_tr_b16 a[0:1], v112 offset:16384
    v_mfma_f32_16x16x32_bf16 v[56:59], a[12:15], a[36:39], v[56:59]
    ds_read_b64_tr_b16 a[2:3], v112 offset:18432
    v_mfma_f32_16x16x32_bf16 v[60:63], a[12:15], a[40:43], v[60:63]
    s_waitcnt lgkmcnt(8)
    v_mfma_f32_16x16x32_bf16 v[64:67], a[16:19], a[32:35], v[64:67]
    ds_read_b64_tr_b16 a[4:5], v113 offset:16384
    v_mfma_f32_16x16x32_bf16 v[68:71], a[16:19], a[36:39], v[68:71]
    ds_read_b64_tr_b16 a[6:7], v113 offset:18432
    v_mfma_f32_16x16x32_bf16 v[72:75], a[16:19], a[40:43], v[72:75]
    s_waitcnt lgkmcnt(8)
    v_mfma_f32_16x16x32_bf16 v[76:79], a[20:23], a[32:35], v[76:79]
    ds_read_b64_tr_b16 a[8:9], v114 offset:16384
    v_mfma_f32_16x16x32_bf16 v[80:83], a[20:23], a[36:39], v[80:83]
    ds_read_b64_tr_b16 a[10:11], v114 offset:18432
    v_mfma_f32_16x16x32_bf16 v[84:87], a[20:23], a[40:43], v[84:87]
    s_waitcnt lgkmcnt(8)
    v_mfma_f32_16x16x32_bf16 v[88:91], a[24:27], a[32:35], v[88:91]
    ds_read_b64_tr_b16 a[12:13], v115 offset:16384
    v_mfma_f32_16x16x32_bf16 v[92:95], a[24:27], a[36:39], v[92:95]
    ds_read_b64_tr_b16 a[14:15], v115 offset:18432
    v_mfma_f32_16x16x32_bf16 v[96:99], a[24:27], a[40:43], v[96:99]
    s_waitcnt lgkmcnt(8)
    v_mfma_f32_16x16x32_bf16 v[100:103], a[28:31], a[32:35], v[100:103]
    ds_read_b64_tr_b16 a[16:17], v116 offset:16384
    v_mfma_f32_16x16x32_bf16 v[104:107], a[28:31], a[36:39], v[104:107]
    ds_read_b64_tr_b16 a[18:19], v116 offset:18432
    v_mfma_f32_16x16x32_bf16 v[108:111], a[28:31], a[40:43], v[108:111]
    s_waitcnt vmcnt(3)
    s_barrier
    s_waitcnt lgkmcnt(8)
    v_mfma_f32_16x16x32_bf16 v[16:19], a[0:3], a[44:47], v[16:19]
    ds_read_b64_tr_b16 a[20:21], v117 offset:16384
    ds_read_b128 a[56:59], v120 offset:24576
    v_mfma_f32_16x16x32_bf16 v[20:23], a[0:3], a[48:51], v[20:23]
    ds_read_b64_tr_b16 a[22:23], v117 offset:18432
    ds_read_b128 a[60:63], v120 offset:26624
    v_mfma_f32_16x16x32_bf16 v[24:27], a[0:3], a[52:55], v[24:27]
    ds_read_b128 a[64:67], v120 offset:28672
    s_waitcnt lgkmcnt(11)
    v_mfma_f32_16x16x32_bf16 v[28:31], a[4:7], a[44:47], v[28:31]
    ds_read_b64_tr_b16 a[24:25], v118 offset:16384
    ds_read_b128 a[68:71], v121 offset:24576
    v_mfma_f32_16x16x32_bf16 v[32:35], a[4:7], a[48:51], v[32:35]
    ds_read_b64_tr_b16 a[26:27], v118 offset:18432
    ds_read_b128 a[72:75], v121 offset:26624
    v_mfma_f32_16x16x32_bf16 v[36:39], a[4:7], a[52:55], v[36:39]
    ds_read_b128 a[76:79], v121 offset:28672
    s_waitcnt lgkmcnt(14)
    v_mfma_f32_16x16x32_bf16 v[40:43], a[8:11], a[44:47], v[40:43]
    ds_read_b64_tr_b16 a[28:29], v119 offset:16384
    v_mfma_f32_16x16x32_bf16 v[44:47], a[8:11], a[48:51], v[44:47]
    ds_read_b64_tr_b16 a[30:31], v119 offset:18432
    v_mfma_f32_16x16x32_bf16 v[48:51], a[8:11], a[52:55], v[48:51]
    s_waitcnt lgkmcnt(14)
    v_mfma_f32_16x16x32_bf16 v[52:55], a[12:15], a[44:47], v[52:55]
    ds_read_b64_tr_b16 a[0:1], v112 offset:32768
    v_mfma_f32_16x16x32_bf16 v[56:59], a[12:15], a[48:51], v[56:59]
    ds_read_b64_tr_b16 a[2:3], v112 offset:34816
    v_mfma_f32_16x16x32_bf16 v[60:63], a[12:15], a[52:55], v[60:63]
    s_waitcnt lgkmcnt(14)
    v_mfma_f32_16x16x32_bf16 v[64:67], a[16:19], a[44:47], v[64:67]
    ds_read_b64_tr_b16 a[4:5], v113 offset:32768
    v_mfma_f32_16x16x32_bf16 v[68:71], a[16:19], a[48:51], v[68:71]
    ds_read_b64_tr_b16 a[6:7], v113 offset:34816
    v_mfma_f32_16x16x32_bf16 v[72:75], a[16:19], a[52:55], v[72:75]
    s_waitcnt lgkmcnt(13)
    v_mfma_f32_16x16x32_bf16 v[76:79], a[20:23], a[44:47], v[76:79]
    ds_read_b64_tr_b16 a[8:9], v114 offset:32768
    v_mfma_f32_16x16x32_bf16 v[80:83], a[20:23], a[48:51], v[80:83]
    ds_read_b64_tr_b16 a[10:11], v114 offset:34816
    v_mfma_f32_16x16x32_bf16 v[84:87], a[20:23], a[52:55], v[84:87]
    s_waitcnt lgkmcnt(10)
    v_mfma_f32_16x16x32_bf16 v[88:91], a[24:27], a[44:47], v[88:91]
    ds_read_b64_tr_b16 a[12:13], v115 offset:32768
    v_mfma_f32_16x16x32_bf16 v[92:95], a[24:27], a[48:51], v[92:95]
    ds_read_b64_tr_b16 a[14:15], v115 offset:34816
    v_mfma_f32_16x16x32_bf16 v[96:99], a[24:27], a[52:55], v[96:99]
    s_waitcnt lgkmcnt(8)
    v_mfma_f32_16x16x32_bf16 v[100:103], a[28:31], a[44:47], v[100:103]
    ds_read_b64_tr_b16 a[16:17], v116 offset:32768
    v_mfma_f32_16x16x32_bf16 v[104:107], a[28:31], a[48:51], v[104:107]
    ds_read_b64_tr_b16 a[18:19], v116 offset:34816
    v_mfma_f32_16x16x32_bf16 v[108:111], a[28:31], a[52:55], v[108:111]
    s_waitcnt vmcnt(0)
    s_barrier
    s_waitcnt lgkmcnt(8)
    v_mfma_f32_16x16x32_bf16 v[16:19], a[0:3], a[56:59], v[16:19]
    ds_read_b64_tr_b16 a[20:21], v117 offset:32768
    v_mfma_f32_16x16x32_bf16 v[20:23], a[0:3], a[60:63], v[20:23]
    ds_read_b64_tr_b16 a[22:23], v117 offset:34816
    s_add_u32 s15, s19, s13
    s_and_b32 s15, s15, 15
    s_lshl_b32 s15, s15, 13
    s_cmp_lt_u32 s19, 16
    s_cselect_b32 s15, s15, 2130706432
    s_add_u32 s19, s19, 1
    s_add_u32 m0, s77, s17
    v_mfma_f32_16x16x32_bf16 v[24:27], a[0:3], a[64:67], v[24:27]
    buffer_load_dwordx4 v9, s[32:35], s15 offen nt lds
    s_waitcnt lgkmcnt(8)
    v_mfma_f32_16x16x32_bf16 v[28:31], a[4:7], a[56:59], v[28:31]
    ds_read_b64_tr_b16 a[24:25], v118 offset:32768
    v_mfma_f32_16x16x32_bf16 v[32:35], a[4:7], a[60:63], v[32:35]
    ds_read_b64_tr_b16 a[26:27], v118 offset:34816
    v_mfma_f32_16x16x32_bf16 v[36:39], a[4:7], a[64:67], v[36:39]
    s_waitcnt lgkmcnt(8)
    v_mfma_f32_16x16x32_bf16 v[40:43], a[8:11], a[56:59], v[40:43]
    ds_read_b64_tr_b16 a[28:29], v119 offset:32768
    s_add_u32 m0, s77, s17
    s_add_u32 m0, m0, 1024
    s_add_u32 s17, s17, 8192
    s_cmp_eq_u32 s17, 24576
    s_cselect_b32 s17, 0, s17
    v_mfma_f32_16x16x32_bf16 v[44:47], a[8:11], a[60:63], v[44:47]
    ds_read_b64_tr_b16 a[30:31], v119 offset:34816
    buffer_load_dwordx4 v10, s[32:35], s15 offen nt lds
    v_mfma_f32_16x16x32_bf16 v[48:51], a[8:11], a[64:67], v[48:51]
    s_waitcnt lgkmcnt(8)
    v_mfma_f32_16x16x32_bf16 v[52:55], a[12:15], a[56:59], v[52:55]
    ds_read_b64_tr_b16 a[0:1], v112 offset:49152
    v_mfma_f32_16x16x32_bf16 v[56:59], a[12:15], a[60:63], v[56:59]
    ds_read_b64_tr_b16 a[2:3], v112 offset:51200
    v_mfma_f32_16x16x32_bf16 v[60:63], a[12:15], a[64:67], v[60:63]
    s_add_u32 s14, s18, s13
    s_and_b32 s14, s14, 15
    s_lshl_b32 s14, s14, 13
    s_cmp_lt_u32 s18, 16
    s_cselect_b32 s14, s14, 2130706432
    s_add_u32 s18, s18, 1
    s_add_u32 m0, s76, s16
    s_waitcnt lgkmcnt(8)
    v_mfma_f32_16x16x32_bf16 v[64:67], a[16:19], a[56:59], v[64:67]
    ds_read_b64_tr_b16 a[4:5], v113 offset:49152
    buffer_load_dwordx4 v7, s[28:31], s14 offen nt lds
    v_mfma_f32_16x16x32_bf16 v[68:71], a[16:19], a[60:63], v[68:71]
    ds_read_b64_tr_b16 a[6:7], v113 offset:51200
    v_mfma_f32_16x16x32_bf16 v[72:75], a[16:19], a[64:67], v[72:75]
    s_waitcnt lgkmcnt(8)
    v_mfma_f32_16x16x32_bf16 v[76:79], a[20:23], a[56:59], v[76:79]
    ds_read_b64_tr_b16 a[8:9], v114 offset:49152
    v_mfma_f32_16x16x32_bf16 v[80:83], a[20:23], a[60:63], v[80:83]
    ds_read_b64_tr_b16 a[10:11], v114 offset:51200
    s_add_u32 m0, s76, s16
    s_add_u32 m0, m0, 1024
    s_add_u32 s16, s16, 8192
    s_cmp_eq_u32 s16, 24576
    s_cselect_b32 s16, 0, s16
    v_mfma_f32_16x16x32_bf16 v[84:87], a[20:23], a[64:67], v[84:87]
    buffer_load_dwordx4 v8, s[28:31], s14 offen nt lds
    s_waitcnt lgkmcnt(8)
    v_mfma_f32_16x16x32_bf16 v[88:91], a[24:27], a[56:59], v[88:91]
    ds_read_b64_tr_b16 a[12:13], v115 offset:49152
    v_mfma_f32_16x16x32_bf16 v[92:95], a[24:27], a[60:63], v[92:95]
    ds_read_b64_tr_b16 a[14:15], v115 offset:51200
    v_mfma_f32_16x16x32_bf16 v[96:99], a[24:27], a[64:67], v[96:99]
    s_waitcnt lgkmcnt(8)
    v_mfma_f32_16x16x32_bf16 v[100:103], a[28:31], a[56:59], v[100:103]
    ds_read_b64_tr_b16 a[16:17], v116 offset:49152
    v_mfma_f32_16x16x32_bf16 v[104:107], a[28:31], a[60:63], v[104:107]
    ds_read_b64_tr_b16 a[18:19], v116 offset:51200
    v_mfma_f32_16x16x32_bf16 v[108:111], a[28:31], a[64:67], v[108:111]
    s_barrier
    s_waitcnt lgkmcnt(8)
    v_mfma_f32_16x16x32_bf16 v[16:19], a[0:3], a[68:71], v[16:19]
    ds_read_b64_tr_b16 a[20:21], v117 offset:49152
    v_mfma_f32_16x16x32_bf16 v[20:23], a[0:3], a[72:75], v[20:23]
    ds_read_b64_tr_b16 a[22:23], v117 offset:51200
    s_add_u32 s15, s19, s13
    s_and_b32 s15, s15, 15
    s_lshl_b32 s15, s15, 13
    s_cmp_lt_u32 s19, 16
    s_cselect_b32 s15, s15, 2130706432
    s_add_u32 s19, s19, 1
    s_add_u32 m0, s77, s17
    v_mfma_f32_16x16x32_bf16 v[24:27], a[0:3], a[76:79], v[24:27]
    buffer_load_dwordx4 v9, s[32:35], s15 offen nt lds
    s_waitcnt lgkmcnt(8)
    v_mfma_f32_16x16x32_bf16 v[28:31], a[4:7], a[68:71], v[28:31]
    ds_read_b64_tr_b16 a[24:25], v118 offset:49152
    v_mfma_f32_16x16x32_bf16 v[32:35], a[4:7], a[72:75], v[32:35]
    ds_read_b64_tr_b16 a[26:27], v118 offset:51200
    v_mfma_f32_16x16x32_bf16 v[36:39], a[4:7], a[76:79], v[36:39]
    s_waitcnt lgkmcnt(8)
    v_mfma_f32_16x16x32_bf16 v[40:43], a[8:11], a[68:71], v[40:43]
    ds_read_b64_tr_b16 a[28:29], v119 offset:49152
    s_add_u32 m0, s77, s17
    s_add_u32 m0, m0, 1024
    s_add_u32 s17, s17, 8192
    s_cmp_eq_u32 s17, 24576
    s_cselect_b32 s17, 0, s17
    v_mfma_f32_16x16x32_bf16 v[44:47], a[8:11], a[72:75], v[44:47]
    ds_read_b64_tr_b16 a[30:31], v119 offset:51200
    buffer_load_dwordx4 v10, s[32:35], s15 offen nt lds
    v_mfma_f32_16x16x32_bf16 v[48:51], a[8:11], a[76:79], v[48:51]
    s_waitcnt lgkmcnt(8)
    v_mfma_f32_16x16x32_bf16 v[52:55], a[12:15], a[68:71], v[52:55]
    v_mfma_f32_16x16x32_bf16 v[56:59], a[12:15], a[72:75], v[56:59]
    v_mfma_f32_16x16x32_bf16 v[60:63], a[12:15], a[76:79], v[60:63]
    s_waitcnt lgkmcnt(6)
    v_mfma_f32_16x16x32_bf16 v[64:67], a[16:19], a[68:71], v[64:67]
    v_mfma_f32_16x16x32_bf16 v[68:71], a[16:19], a[72:75], v[68:71]
    v_mfma_f32_16x16x32_bf16 v[72:75], a[16:19], a[76:79], v[72:75]
    s_waitcnt lgkmcnt(4)
    v_mfma_f32_16x16x32_bf16 v[76:79], a[20:23], a[68:71], v[76:79]
    v_mfma_f32_16x16x32_bf16 v[80:83], a[20:23], a[72:75], v[80:83]
    v_mfma_f32_16x16x32_bf16 v[84:87], a[20:23], a[76:79], v[84:87]
    s_waitcnt lgkmcnt(2)
    v_mfma_f32_16x16x32_bf16 v[88:91], a[24:27], a[68:71], v[88:91]
    v_mfma_f32_16x16x32_bf16 v[92:95], a[24:27], a[72:75], v[92:95]
    v_mfma_f32_16x16x32_bf16 v[96:99], a[24:27], a[76:79], v[96:99]
    s_waitcnt lgkmcnt(0)
    v_mfma_f32_16x16x32_bf16 v[100:103], a[28:31], a[68:71], v[100:103]
    v_mfma_f32_16x16x32_bf16 v[104:107], a[28:31], a[72:75], v[104:107]
    v_mfma_f32_16x16x32_bf16 v[108:111], a[28:31], a[76:79], v[108:111]
    s_barrier
    ds_read_b128 a[0:3], v1 offset:0
    ds_read_b128 a[4:7], v2 offset:0
    ds_read_b128 a[8:11], v3 offset:0
    ds_read_b128 a[12:15], v4 offset:0
    ds_read_b128 a[16:19], v1 offset:4096
    ds_read_b128 a[20:23], v2 offset:4096
    ds_read_b128 a[24:27], v3 offset:4096
    ds_read_b128 a[28:31], v4 offset:4096
    v_pk_mul_f32 v[64:65], v[64:65], s[68:69]
    v_pk_mul_f32 v[66:67], v[66:67], s[68:69]
    v_pk_mul_f32 v[76:77], v[76:77], s[68:69]
    v_pk_mul_f32 v[78:79], v[78:79], s[68:69]
    v_cvt_pk_bf16_f32 v11, v64, v65
    v_cvt_pk_bf16_f32 v12, v66, v67
    v_cvt_pk_bf16_f32 v13, v76, v77
    v_cvt_pk_bf16_f32 v14, v78, v79
    v_cndmask_b32 v120, v11, v13, s[66:67]
    v_cndmask_b32 v121, v12, v14, s[66:67]
    v_cndmask_b32 v122, v13, v11, s[66:67]
    v_cndmask_b32 v123, v14, v12, s[66:67]
    v_pk_mul_f32 v[68:69], v[68:69], s[68:69]
    v_pk_mul_f32 v[70:71], v[70:71], s[68:69]
    v_pk_mul_f32 v[80:81], v[80:81], s[68:69]
    v_pk_mul_f32 v[82:83], v[82:83], s[68:69]
    v_cvt_pk_bf16_f32 v11, v68, v69
    v_cvt_pk_bf16_f32 v12, v70, v71
    v_cvt_pk_bf16_f32 v13, v80, v81
    v_cvt_pk_bf16_f32 v14, v82, v83
    v_cndmask_b32 v136, v11, v13, s[66:67]
    v_cndmask_b32 v137, v12, v14, s[66:67]
    v_cndmask_b32 v138, v13, v11, s[66:67]
    v_cndmask_b32 v139, v14, v12, s[66:67]
    v_pk_mul_f32 v[72:73], v[72:73], s[68:69]
    v_pk_mul_f32 v[74:75], v[74:75], s[68:69]
    v_pk_mul_f32 v[84:85], v[84:85], s[68:69]
    v_pk_mul_f32 v[86:87], v[86:87], s[68:69]
    v_cvt_pk_bf16_f32 v11, v72, v73
    v_cvt_pk_bf16_f32 v12, v74, v75
    v_cvt_pk_bf16_f32 v13, v84, v85
    v_cvt_pk_bf16_f32 v14, v86, v87
    v_cndmask_b32 v152, v11, v13, s[66:67]
    v_cndmask_b32 v153, v12, v14, s[66:67]
    v_cndmask_b32 v154, v13, v11, s[66:67]
    v_cndmask_b32 v155, v14, v12, s[66:67]
    s_waitcnt lgkmcnt(0)
    v_mfma_f32_16x16x32_bf16 v[64:67], a[8:11], v[120:123], 0
    v_pk_mul_f32 v[88:89], v[88:89], s[68:69]
    v_pk_mul_f32 v[90:91], v[90:91], s[68:69]
    v_pk_mul_f32 v[100:101], v[100:101], s[68:69]
    v_pk_mul_f32 v[102:103], v[102:103], s[68:69]
    v_cvt_pk_bf16_f32 v11, v88, v89
    v_cvt_pk_bf16_f32 v12, v90, v91
    v_mfma_f32_16x16x32_bf16 v[68:71], a[8:11], v[136:139], 0
    v_cvt_pk_bf16_f32 v13, v100, v101
    v_cvt_pk_bf16_f32 v14, v102, v103
    v_cndmask_b32 v124, v11, v13, s[66:67]
    v_cndmask_b32 v125, v12, v14, s[66:67]
    v_cndmask_b32 v126, v13, v11, s[66:67]
    v_cndmask_b32 v127, v14, v12, s[66:67]
    v_mfma_f32_16x16x32_bf16 v[72:75], a[8:11], v[152:155], 0
    v_pk_mul_f32 v[92:93], v[92:93], s[68:69]
    v_pk_mul_f32 v[94:95], v[94:95], s[68:69]
    v_pk_mul_f32 v[104:105], v[104:105], s[68:69]
    v_pk_mul_f32 v[106:107], v[106:107], s[68:69]
    v_cvt_pk_bf16_f32 v11, v92, v93
    v_cvt_pk_bf16_f32 v12, v94, v95
    v_mfma_f32_16x16x32_bf16 v[76:79], a[24:27], v[120:123], 0
    v_cvt_pk_bf16_f32 v13, v104, v105
    v_cvt_pk_bf16_f32 v14, v106, v107
    v_cndmask_b32 v140, v11, v13, s[66:67]
    v_cndmask_b32 v141, v12, v14, s[66:67]
    v_cndmask_b32 v142, v13, v11, s[66:67]
    v_cndmask_b32 v143, v14, v12, s[66:67]
    v_mfma_f32_16x16x32_bf16 v[80:83], a[24:27], v[136:139], 0
    v_pk_mul_f32 v[96:97], v[96:97], s[68:69]
    v_pk_mul_f32 v[98:99], v[98:99], s[68:69]
    v_pk_mul_f32 v[108:109], v[108:109], s[68:69]
    v_pk_mul_f32 v[110:111], v[110:111], s[68:69]
    v_cvt_pk_bf16_f32 v11, v96, v97
    v_cvt_pk_bf16_f32 v12, v98, v99
    v_mfma_f32_16x16x32_bf16 v[84:87], a[24:27], v[152:155], 0
    v_cvt_pk_bf16_f32 v13, v108, v109
    v_cvt_pk_bf16_f32 v14, v110, v111
    v_cndmask_b32 v156, v11, v13, s[66:67]
    v_cndmask_b32 v157, v12, v14, s[66:67]
    v_cndmask_b32 v158, v13, v11, s[66:67]
    v_cndmask_b32 v159, v14, v12, s[66:67]
    v_mfma_f32_16x16x32_bf16 v[64:67], a[12:15], v[124:127], v[64:67]
    v_pk_mul_f32 v[16:17], v[16:17], s[68:69]
    v_pk_mul_f32 v[18:19], v[18:19], s[68:69]
    v_pk_mul_f32 v[28:29], v[28:29], s[68:69]
    v_pk_mul_f32 v[30:31], v[30:31], s[68:69]
    v_cvt_pk_bf16_f32 v11, v16, v17
    v_cvt_pk_bf16_f32 v12, v18, v19
    v_mfma_f32_16x16x32_bf16 v[68:71], a[12:15], v[140:143], v[68:71]
    v_cvt_pk_bf16_f32 v13, v28, v29
    v_cvt_pk_bf16_f32 v14, v30, v31
    v_cndmask_b32 v112, v11, v13, s[66:67]
    v_cndmask_b32 v113, v12, v14, s[66:67]
    v_cndmask_b32 v114, v13, v11, s[66:67]
    v_cndmask_b32 v115, v14, v12, s[66:67]
    v_mfma_f32_16x16x32_bf16 v[72:75], a[12:15], v[156:159], v[72:75]
    v_pk_mul_f32 v[20:21], v[20:21], s[68:69]
    v_pk_mul_f32 v[22:23], v[22:23], s[68:69]
    v_pk_mul_f32 v[32:33], v[32:33], s[68:69]
    v_pk_mul_f32 v[34:35], v[34:35], s[68:69]
    v_cvt_pk_bf16_f32 v11, v20, v21
    v_cvt_pk_bf16_f32 v12, v22, v23
    v_mfma_f32_16x16x32_bf16 v[76:79], a[28:31], v[124:127], v[76:79]
    v_cvt_pk_bf16_f32 v13, v32, v33
    v_cvt_pk_bf16_f32 v14, v34, v35
    v_cndmask_b32 v128, v11, v13, s[66:67]
    v_cndmask_b32 v129, v12, v14, s[66:67]
    v_cndmask_b32 v130, v13, v11, s[66:67]
    v_cndmask_b32 v131, v14, v12, s[66:67]
    v_mfma_f32_16x16x32_bf16 v[80:83], a[28:31], v[140:143], v[80:83]
    v_pk_mul_f32 v[24:25], v[24:25], s[68:69]
    v_pk_mul_f32 v[26:27], v[26:27], s[68:69]
    v_pk_mul_f32 v[36:37], v[36:37], s[68:69]
    v_pk_mul_f32 v[38:39], v[38:39], s[68:69]
    v_cvt_pk_bf16_f32 v11, v24, v25
    v_cvt_pk_bf16_f32 v12, v26, v27
    v_mfma_f32_16x16x32_bf16 v[84:87], a[28:31], v[156:159], v[84:87]
    v_cvt_pk_bf16_f32 v13, v36, v37
    v_cvt_pk_bf16_f32 v14, v38, v39
    v_cndmask_b32 v144, v11, v13, s[66:67]
    v_cndmask_b32 v145, v12, v14, s[66:67]
    v_cndmask_b32 v146, v13, v11, s[66:67]
    v_cndmask_b32 v147, v14, v12, s[66:67]
    v_mfma_f32_16x16x32_bf16 v[64:67], a[0:3], v[112:115], v[64:67]
    v_pk_mul_f32 v[40:41], v[40:41], s[68:69]
    v_pk_mul_f32 v[42:43], v[42:43], s[68:69]
    v_pk_mul_f32 v[52:53], v[52:53], s[68:69]
    v_pk_mul_f32 v[54:55], v[54:55], s[68:69]
    v_cvt_pk_bf16_f32 v11, v40, v41
    v_cvt_pk_bf16_f32 v12, v42, v43
    v_mfma_f32_16x16x32_bf16 v[68:71], a[0:3], v[128:131], v[68:71]
    v_cvt_pk_bf16_f32 v13, v52, v53
    v_cvt_pk_bf16_f32 v14, v54, v55
    v_cndmask_b32 v116, v11, v13, s[66:67]
    v_cndmask_b32 v117, v12, v14, s[66:67]
    v_cndmask_b32 v118, v13, v11, s[66:67]
    v_cndmask_b32 v119, v14, v12, s[66:67]
    v_mfma_f32_16x16x32_bf16 v[72:75], a[0:3], v[144:147], v[72:75]
    v_pk_mul_f32 v[44:45], v[44:45], s[68:69]
    v_pk_mul_f32 v[46:47], v[46:47], s[68:69]
    v_pk_mul_f32 v[56:57], v[56:57], s[68:69]
    v_pk_mul_f32 v[58:59], v[58:59], s[68:69]
    v_cvt_pk_bf16_f32 v11, v44, v45
    v_cvt_pk_bf16_f32 v12, v46, v47
    v_mfma_f32_16x16x32_bf16 v[76:79], a[16:19], v[112:115], v[76:79]
    v_cvt_pk_bf16_f32 v13, v56, v57
    v_cvt_pk_bf16_f32 v14, v58, v59
    v_cndmask_b32 v132, v11, v13, s[66:67]
    v_cndmask_b32 v133, v12, v14, s[66:67]
    v_cndmask_b32 v134, v13, v11, s[66:67]
    v_cndmask_b32 v135, v14, v12, s[66:67]
    v_mfma_f32_16x16x32_bf16 v[80:83], a[16:19], v[128:131], v[80:83]
    v_pk_mul_f32 v[48:49], v[48:49], s[68:69]
    v_pk_mul_f32 v[50:51], v[50:51], s[68:69]
    v_pk_mul_f32 v[60:61], v[60:61], s[68:69]
    v_pk_mul_f32 v[62:63], v[62:63], s[68:69]
    v_cvt_pk_bf16_f32 v11, v48, v49
    v_cvt_pk_bf16_f32 v12, v50, v51
    v_mfma_f32_16x16x32_bf16 v[84:87], a[16:19], v[144:147], v[84:87]
    v_cvt_pk_bf16_f32 v13, v60, v61
    v_cvt_pk_bf16_f32 v14, v62, v63
    v_cndmask_b32 v148, v11, v13, s[66:67]
    v_cndmask_b32 v149, v12, v14, s[66:67]
    v_cndmask_b32 v150, v13, v11, s[66:67]
    v_cndmask_b32 v151, v14, v12, s[66:67]
    v_mfma_f32_16x16x32_bf16 v[64:67], a[4:7], v[116:119], v[64:67]
    v_mfma_f32_16x16x32_bf16 v[68:71], a[4:7], v[132:135], v[68:71]
    v_mfma_f32_16x16x32_bf16 v[72:75], a[4:7], v[148:151], v[72:75]
    v_mfma_f32_16x16x32_bf16 v[76:79], a[20:23], v[116:119], v[76:79]
    v_mfma_f32_16x16x32_bf16 v[80:83], a[20:23], v[132:135], v[80:83]
    v_mfma_f32_16x16x32_bf16 v[84:87], a[20:23], v[148:151], v[84:87]
    v_mov_b32 v13, 0
    v_mov_b32 v14, 0
    v_mov_b32 v15, 0
    v_max3_f32 v52, v64, v65, v66
    s_nop 1
    v_max3_f32 v52, v52, v67, v76
    v_max3_f32 v52, v52, v77, v78
    v_max_f32 v52, v52, v79
    v_max3_f32 v53, v68, v69, v70
    v_max3_f32 v53, v53, v71, v80
    v_max3_f32 v53, v53, v81, v82
    v_max_f32 v53, v53, v83
    v_max3_f32 v54, v72, v73, v74
    v_max3_f32 v54, v54, v75, v84
    v_max3_f32 v54, v54, v85, v86
    v_max_f32 v54, v54, v87
    v_accvgpr_write_b32 a0, 0
    v_accvgpr_write_b32 a1, 0
    v_accvgpr_write_b32 a2, 0
    v_accvgpr_write_b32 a3, 0
    v_accvgpr_write_b32 a4, 0
    v_accvgpr_write_b32 a5, 0
    v_accvgpr_write_b32 a6, 0
    v_accvgpr_write_b32 a7, 0
    v_accvgpr_write_b32 a8, 0
    v_accvgpr_write_b32 a9, 0
    v_accvgpr_write_b32 a10, 0
    v_accvgpr_write_b32 a11, 0
    v_accvgpr_write_b32 a12, 0
    v_accvgpr_write_b32 a13, 0
    v_accvgpr_write_b32 a14, 0
    v_accvgpr_write_b32 a15, 0
    v_accvgpr_write_b32 a16, 0
    v_accvgpr_write_b32 a17, 0
    v_accvgpr_write_b32 a18, 0
    v_accvgpr_write_b32 a19, 0
    v_accvgpr_write_b32 a20, 0
    v_accvgpr_write_b32 a21, 0
    v_accvgpr_write_b32 a22, 0
    v_accvgpr_write_b32 a23, 0
    v_accvgpr_write_b32 a24, 0
    v_accvgpr_write_b32 a25, 0
    v_accvgpr_write_b32 a26, 0
    v_accvgpr_write_b32 a27, 0
    v_accvgpr_write_b32 a28, 0
    v_accvgpr_write_b32 a29, 0
    v_accvgpr_write_b32 a30, 0
    v_accvgpr_write_b32 a31, 0
    v_accvgpr_write_b32 a32, 0
    v_accvgpr_write_b32 a33, 0
    v_accvgpr_write_b32 a34, 0
    v_accvgpr_write_b32 a35, 0
    v_accvgpr_write_b32 a36, 0
    v_accvgpr_write_b32 a37, 0
    v_accvgpr_write_b32 a38, 0
    v_accvgpr_write_b32 a39, 0
    v_accvgpr_write_b32 a40, 0
    v_accvgpr_write_b32 a41, 0
    v_accvgpr_write_b32 a42, 0
    v_accvgpr_write_b32 a43, 0
    v_accvgpr_write_b32 a44, 0
    v_accvgpr_write_b32 a45, 0
    v_accvgpr_write_b32 a46, 0
    v_accvgpr_write_b32 a47, 0
    v_accvgpr_write_b32 a48, 0
    v_accvgpr_write_b32 a49, 0
    v_accvgpr_write_b32 a50, 0
    v_accvgpr_write_b32 a51, 0
    v_accvgpr_write_b32 a52, 0
    v_accvgpr_write_b32 a53, 0
    v_accvgpr_write_b32 a54, 0
    v_accvgpr_write_b32 a55, 0
    v_accvgpr_write_b32 a56, 0
    v_accvgpr_write_b32 a57, 0
    v_accvgpr_write_b32 a58, 0
    v_accvgpr_write_b32 a59, 0
    v_accvgpr_write_b32 a60, 0
    v_accvgpr_write_b32 a61, 0
    v_accvgpr_write_b32 a62, 0
    v_accvgpr_write_b32 a63, 0
    v_accvgpr_write_b32 a64, 0
    v_accvgpr_write_b32 a65, 0
    v_accvgpr_write_b32 a66, 0
    v_accvgpr_write_b32 a67, 0
    v_accvgpr_write_b32 a68, 0
    v_accvgpr_write_b32 a69, 0
    v_accvgpr_write_b32 a70, 0
    v_accvgpr_write_b32 a71, 0
    v_accvgpr_write_b32 a72, 0
    v_accvgpr_write_b32 a73, 0
    v_accvgpr_write_b32 a74, 0
    v_accvgpr_write_b32 a75, 0
    v_accvgpr_write_b32 a76, 0
    v_accvgpr_write_b32 a77, 0
    v_accvgpr_write_b32 a78, 0
    v_accvgpr_write_b32 a79, 0
    v_mov_b32 v56, v52
    v_mov_b32 v57, v53
    v_mov_b32 v58, v54
    v_permlane16_swap_b32 v52, v56
    v_permlane16_swap_b32 v53, v57
    v_permlane16_swap_b32 v54, v58
    v_max_f32 v52, v52, v56
    v_max_f32 v53, v53, v57
    v_max_f32 v54, v54, v58
    v_mov_b32 v56, v52
    v_mov_b32 v57, v53
    v_mov_b32 v58, v54
    v_permlane32_swap_b32 v52, v56
    v_permlane32_swap_b32 v53, v57
    v_permlane32_swap_b32 v54, v58
    v_max_f32 v52, v52, v56
    v_max_f32 v53, v53, v57
    v_max_f32 v54, v54, v58
    v_sub_f32 v40, 0, v52
    v_sub_f32 v41, 0, v52
    v_sub_f32 v42, 0, v52
    v_sub_f32 v43, 0, v52
    v_sub_f32 v44, 0, v53
    v_sub_f32 v45, 0, v53
    v_sub_f32 v46, 0, v53
    v_sub_f32 v47, 0, v53
    v_sub_f32 v48, 0, v54
    v_sub_f32 v49, 0, v54
    v_sub_f32 v50, 0, v54
    v_sub_f32 v51, 0, v54
    v_sub_f32 v64, v64, v52
    v_sub_f32 v65, v65, v52
    v_sub_f32 v66, v66, v52
    v_sub_f32 v67, v67, v52
    v_sub_f32 v68, v68, v53
    v_sub_f32 v69, v69, v53
    v_sub_f32 v70, v70, v53
    v_sub_f32 v71, v71, v53
    v_sub_f32 v72, v72, v54
    v_sub_f32 v73, v73, v54
    v_sub_f32 v74, v74, v54
    v_sub_f32 v75, v75, v54
    v_sub_f32 v76, v76, v52
    v_sub_f32 v77, v77, v52
    v_sub_f32 v78, v78, v52
    v_sub_f32 v79, v79, v52
    v_sub_f32 v80, v80, v53
    v_sub_f32 v81, v81, v53
    v_sub_f32 v82, v82, v53
    v_sub_f32 v83, v83, v53
    v_sub_f32 v84, v84, v54
    v_sub_f32 v85, v85, v54
    v_sub_f32 v86, v86, v54
    v_sub_f32 v87, v87, v54
L_P0:
    s_waitcnt vmcnt(4)
    s_barrier
    v_lshlrev_b32 v11, 3, v0
    buffer_load_dword v12, v11, s[48:51], 0 offen
    v_add_u32 v1, 8192, v1
    v_add_u32 v2, 8192, v2
    v_add_u32 v3, 8192, v3
    v_add_u32 v4, 8192, v4
    s_mov_b32 s42, 8192
    s_mov_b32 s43, 0
    s_mov_b32 s12, -16384
    s_mov_b32 s79, 8192
    ds_read_b128 v[16:19], v1 offset:0
    ds_read_b128 v[20:23], v2 offset:0
    ds_read_b128 v[24:27], v3 offset:0
    ds_read_b128 v[28:31], v4 offset:0
    v_exp_f32 v64, v64
    v_exp_f32 v68, v68
    v_exp_f32 v72, v72
    v_add_f32 v13, v13, v64
    v_exp_f32 v65, v65
    v_add_f32 v14, v14, v68
    v_exp_f32 v69, v69
    v_add_f32 v15, v15, v72
    v_exp_f32 v73, v73
    v_add_f32 v13, v13, v65
    v_exp_f32 v66, v66
    v_add_f32 v14, v14, v69
    v_exp_f32 v70, v70
    v_add_f32 v15, v15, v73
    v_exp_f32 v74, v74
    v_add_f32 v13, v13, v66
    v_exp_f32 v67, v67
    v_add_f32 v14, v14, v70
    v_exp_f32 v71, v71
    v_add_f32 v15, v15, v74
    v_exp_f32 v75, v75
    v_add_f32 v13, v13, v67
    v_add_f32 v14, v14, v71
    v_add_f32 v15, v15, v75
    s_mov_b32 s72, 0
.p2align 6
L_att_loop:
    s_waitcnt lgkmcnt(3)
    v_mfma_f32_16x16x32_bf16 v[88:91], v[16:19], v[112:115], v[40:43]
    ds_read_b128 v[32:35], v1 offset:4096
    v_cvt_pk_bf16_f32 v52, v64, v65
    v_cvt_pk_bf16_f32 v53, v66, v67
    v_mfma_f32_16x16x32_bf16 v[92:95], v[16:19], v[128:131], v[44:47]
    v_cvt_pk_bf16_f32 v56, v68, v69
    v_cvt_pk_bf16_f32 v57, v70, v71
    v_mfma_f32_16x16x32_bf16 v[96:99], v[16:19], v[144:147], v[48:51]
    v_cvt_pk_bf16_f32 v60, v72, v73
    v_cvt_pk_bf16_f32 v61, v74, v75
    s_waitcnt lgkmcnt(3)
    v_mfma_f32_16x16x32_bf16 v[88:91], v[20:23], v[116:119], v[88:91]
    ds_read_b128 v[16:19], v2 offset:4096
    v_exp_f32 v76, v76
    v_mfma_f32_16x16x32_bf16 v[92:95], v[20:23], v[132:135], v[92:95]
    v_exp_f32 v80, v80
    v_mfma_f32_16x16x32_bf16 v[96:99], v[20:23], v[148:151], v[96:99]
    v_exp_f32 v84, v84
    v_add_f32 v13, v13, v76
    s_waitcnt lgkmcnt(3)
    v_mfma_f32_16x16x32_bf16 v[88:91], v[24:27], v[120:123], v[88:91]
    ds_read_b128 v[20:23], v3 offset:4096
    v_exp_f32 v77, v77
    v_mfma_f32_16x16x32_bf16 v[92:95], v[24:27], v[136:139], v[92:95]
    v_add_f32 v14, v14, v80
    v_exp_f32 v81, v81
    v_mfma_f32_16x16x32_bf16 v[96:99], v[24:27], v[152:155], v[96:99]
    v_add_f32 v15, v15, v84
    s_waitcnt lgkmcnt(3)
    v_mfma_f32_16x16x32_bf16 v[88:91], v[28:31], v[124:127], v[88:91]
    ds_read_b128 v[24:27], v4 offset:4096
    v_exp_f32 v85, v85
    v_mfma_f32_16x16x32_bf16 v[92:95], v[28:31], v[140:143], v[92:95]
    v_add_f32 v13, v13, v77
    v_exp_f32 v78, v78
    v_mfma_f32_16x16x32_bf16 v[96:99], v[28:31], v[156:159], v[96:99]
    v_add_f32 v14, v14, v81
    s_waitcnt lgkmcnt(3)
    v_mfma_f32_16x16x32_bf16 v[100:103], v[32:35], v[112:115], v[40:43]
    ds_read_b64_tr_b16 v[28:29], v5 offset:0
    v_exp_f32 v82, v82
    v_mfma_f32_16x16x32_bf16 v[104:107], v[32:35], v[128:131], v[44:47]
    ds_read_b64_tr_b16 v[30:31], v5 offset:4096
    v_add_f32 v15, v15, v85
    v_exp_f32 v86, v86
    v_mfma_f32_16x16x32_bf16 v[108:111], v[32:35], v[144:147], v[48:51]
    v_add_f32 v13, v13, v78
    s_waitcnt lgkmcnt(4)
    v_mfma_f32_16x16x32_bf16 v[100:103], v[16:19], v[116:119], v[100:103]
    ds_read_b64_tr_b16 v[36:37], v6 offset:128
    v_exp_f32 v79, v79
    v_mfma_f32_16x16x32_bf16 v[104:107], v[16:19], v[132:135], v[104:107]
    ds_read_b64_tr_b16 v[38:39], v6 offset:4224
    v_add_f32 v14, v14, v82
    v_mfma_f32_16x16x32_bf16 v[108:111], v[16:19], v[148:151], v[108:111]
    v_exp_f32 v83, v83
    v_add_f32 v15, v15, v86
    s_waitcnt lgkmcnt(5)
    v_mfma_f32_16x16x32_bf16 v[100:103], v[20:23], v[120:123], v[100:103]
    ds_read_b64_tr_b16 v[16:17], v5 offset:256
    v_exp_f32 v87, v87
    v_mfma_f32_16x16x32_bf16 v[104:107], v[20:23], v[136:139], v[104:107]
    ds_read_b64_tr_b16 v[18:19], v5 offset:4352
    v_add_f32 v13, v13, v79
    v_mfma_f32_16x16x32_bf16 v[108:111], v[20:23], v[152:155], v[108:111]
    v_add_f32 v14, v14, v83
    v_add_f32 v15, v15, v87
    s_waitcnt lgkmcnt(6)
    v_mfma_f32_16x16x32_bf16 v[100:103], v[24:27], v[124:127], v[100:103]
    ds_read_b64_tr_b16 v[20:21], v6 offset:384
    v_cvt_pk_bf16_f32 v54, v76, v77
    v_cvt_pk_bf16_f32 v55, v78, v79
    v_mfma_f32_16x16x32_bf16 v[104:107], v[24:27], v[140:143], v[104:107]
    ds_read_b64_tr_b16 v[22:23], v6 offset:4480
    v_cvt_pk_bf16_f32 v58, v80, v81
    v_mfma_f32_16x16x32_bf16 v[108:111], v[24:27], v[156:159], v[108:111]
    v_cvt_pk_bf16_f32 v59, v82, v83
    v_cvt_pk_bf16_f32 v62, v84, v85
    v_cvt_pk_bf16_f32 v63, v86, v87
    s_waitcnt vmcnt(0)
    s_barrier
    s_waitcnt lgkmcnt(6)
    v_mfma_f32_16x16x32_bf16 a[0:3], v[28:31], v[52:55], a[0:3]
    ds_read_b64_tr_b16 v[24:25], v5 offset:512
    s_add_u32 s42, s42, 8192
    s_cmp_eq_u32 s42, 24576
    s_cselect_b32 s40, s12, s79
    s_cselect_b32 s42, 0, s42
    v_mfma_f32_16x16x32_bf16 a[4:7], v[28:31], v[56:59], a[4:7]
    ds_read_b64_tr_b16 v[26:27], v5 offset:4608
    s_add_u32 s15, s19, s13
    s_and_b32 s15, s15, 15
    s_lshl_b32 s15, s15, 13
    s_cmp_lt_u32 s19, 16
    s_cselect_b32 s15, s15, 2130706432
    s_add_u32 s19, s19, 1
    s_add_u32 m0, s77, s17
    v_add_u32 v1, s40, v1
    v_mfma_f32_16x16x32_bf16 a[8:11], v[28:31], v[60:63], a[8:11]
    buffer_load_dwordx4 v9, s[32:35], s15 offen nt lds
    v_add_u32 v2, s40, v2
    s_waitcnt lgkmcnt(6)
    v_mfma_f32_16x16x32_bf16 a[12:15], v[36:39], v[52:55], a[12:15]
    ds_read_b64_tr_b16 v[28:29], v6 offset:640
    v_add_u32 v3, s40, v3
    v_mfma_f32_16x16x32_bf16 a[16:19], v[36:39], v[56:59], a[16:19]
    ds_read_b64_tr_b16 v[30:31], v6 offset:4736
    v_add_u32 v4, s40, v4
    v_exp_f32 v88, v88
    v_mfma_f32_16x16x32_bf16 a[20:23], v[36:39], v[60:63], a[20:23]
    v_exp_f32 v92, v92
    s_waitcnt lgkmcnt(6)
    v_mfma_f32_16x16x32_bf16 a[24:27], v[16:19], v[52:55], a[24:27]
    ds_read_b64_tr_b16 v[32:33], v5 offset:768
    s_add_u32 m0, s77, s17
    s_add_u32 m0, m0, 1024
    s_add_u32 s17, s17, 8192
    s_cmp_eq_u32 s17, 24576
    s_cselect_b32 s17, 0, s17
    v_mfma_f32_16x16x32_bf16 a[28:31], v[16:19], v[56:59], a[28:31]
    ds_read_b64_tr_b16 v[34:35], v5 offset:4864
    buffer_load_dwordx4 v10, s[32:35], s15 offen nt lds
    v_mfma_f32_16x16x32_bf16 a[32:35], v[16:19], v[60:63], a[32:35]
    v_exp_f32 v96, v96
    v_add_f32 v13, v13, v88
    s_waitcnt lgkmcnt(6)
    v_mfma_f32_16x16x32_bf16 a[36:39], v[20:23], v[52:55], a[36:39]
    ds_read_b64_tr_b16 v[36:37], v6 offset:896
    v_exp_f32 v89, v89
    v_add_f32 v14, v14, v92
    v_mfma_f32_16x16x32_bf16 a[40:43], v[20:23], v[56:59], a[40:43]
    ds_read_b64_tr_b16 v[38:39], v6 offset:4992
    v_exp_f32 v93, v93
    v_mfma_f32_16x16x32_bf16 a[44:47], v[20:23], v[60:63], a[44:47]
    s_add_u32 s14, s18, s13
    s_and_b32 s14, s14, 15
    s_lshl_b32 s14, s14, 13
    s_cmp_lt_u32 s18, 16
    s_cselect_b32 s14, s14, 2130706432
    s_add_u32 s18, s18, 1
    s_add_u32 m0, s76, s16
    s_waitcnt lgkmcnt(6)
    v_mfma_f32_16x16x32_bf16 a[48:51], v[24:27], v[52:55], a[48:51]
    ds_read_b128 v[16:19], v1 offset:0
    buffer_load_dwordx4 v7, s[28:31], s14 offen nt lds
    v_add_f32 v15, v15, v96
    v_mfma_f32_16x16x32_bf16 a[52:55], v[24:27], v[56:59], a[52:55]
    v_exp_f32 v97, v97
    v_add_f32 v13, v13, v89
    v_mfma_f32_16x16x32_bf16 a[56:59], v[24:27], v[60:63], a[56:59]
    v_exp_f32 v90, v90
    v_add_f32 v14, v14, v93
    s_waitcnt lgkmcnt(5)
    v_mfma_f32_16x16x32_bf16 a[60:63], v[28:31], v[52:55], a[60:63]
    ds_read_b128 v[20:23], v2 offset:0
    v_exp_f32 v94, v94
    v_mfma_f32_16x16x32_bf16 a[64:67], v[28:31], v[56:59], a[64:67]
    s_add_u32 m0, s76, s16
    s_add_u32 m0, m0, 1024
    s_add_u32 s16, s16, 8192
    s_cmp_eq_u32 s16, 24576
    s_cselect_b32 s16, 0, s16
    v_add_f32 v15, v15, v97
    v_mfma_f32_16x16x32_bf16 a[68:71], v[28:31], v[60:63], a[68:71]
    buffer_load_dwordx4 v8, s[28:31], s14 offen nt lds
    v_exp_f32 v98, v98
    s_waitcnt lgkmcnt(4)
    v_mfma_f32_16x16x32_bf16 a[72:75], v[32:35], v[52:55], a[72:75]
    ds_read_b128 v[24:27], v3 offset:0
    s_add_u32 s43, s43, 8192
    s_cmp_eq_u32 s43, 24576
    s_cselect_b32 s40, s12, s79
    s_cselect_b32 s43, 0, s43
    v_mfma_f32_16x16x32_bf16 a[76:79], v[32:35], v[56:59], a[76:79]
    v_add_u32 v5, s40, v5
    v_add_f32 v13, v13, v90
    v_mfma_f32_16x16x32_bf16 a[80:83], v[32:35], v[60:63], a[80:83]
    v_add_u32 v6, s40, v6
    v_exp_f32 v91, v91
    s_waitcnt lgkmcnt(3)
    v_mfma_f32_16x16x32_bf16 a[84:87], v[36:39], v[52:55], a[84:87]
    ds_read_b128 v[28:31], v4 offset:0
    v_add_f32 v14, v14, v94
    v_exp_f32 v95, v95
    v_mfma_f32_16x16x32_bf16 a[88:91], v[36:39], v[56:59], a[88:91]
    v_add_f32 v15, v15, v98
    v_exp_f32 v99, v99
    v_mfma_f32_16x16x32_bf16 a[92:95], v[36:39], v[60:63], a[92:95]
    v_add_f32 v13, v13, v91
    v_add_f32 v14, v14, v95
    v_add_f32 v15, v15, v99
    s_cmp_eq_u32 s72, 7
    s_cbranch_scc1 L_att_tail
    s_waitcnt lgkmcnt(3)
    v_mfma_f32_16x16x32_bf16 v[64:67], v[16:19], v[112:115], v[40:43]
    ds_read_b128 v[32:35], v1 offset:4096
    v_cvt_pk_bf16_f32 v52, v88, v89
    v_cvt_pk_bf16_f32 v53, v90, v91
    v_mfma_f32_16x16x32_bf16 v[68:71], v[16:19], v[128:131], v[44:47]
    v_cvt_pk_bf16_f32 v56, v92, v93
    v_cvt_pk_bf16_f32 v57, v94, v95
    v_mfma_f32_16x16x32_bf16 v[72:75], v[16:19], v[144:147], v[48:51]
    v_cvt_pk_bf16_f32 v60, v96, v97
    v_cvt_pk_bf16_f32 v61, v98, v99
    s_waitcnt lgkmcnt(3)
    v_mfma_f32_16x16x32_bf16 v[64:67], v[20:23], v[116:119], v[64:67]
    ds_read_b128 v[16:19], v2 offset:4096
    v_exp_f32 v100, v100
    v_mfma_f32_16x16x32_bf16 v[68:71], v[20:23], v[132:135], v[68:71]
    v_exp_f32 v104, v104
    v_mfma_f32_16x16x32_bf16 v[72:75], v[20:23], v[148:151], v[72:75]
    v_exp_f32 v108, v108
    v_add_f32 v13, v13, v100
    s_waitcnt lgkmcnt(3)
    v_mfma_f32_16x16x32_bf16 v[64:67], v[24:27], v[120:123], v[64:67]
    ds_read_b128 v[20:23], v3 offset:4096
    v_exp_f32 v101, v101
    v_mfma_f32_16x16x32_bf16 v[68:71], v[24:27], v[136:139], v[68:71]
    v_add_f32 v14, v14, v104
    v_exp_f32 v105, v105
    v_mfma_f32_16x16x32_bf16 v[72:75], v[24:27], v[152:155], v[72:75]
    v_add_f32 v15, v15, v108
    s_waitcnt lgkmcnt(3)
    v_mfma_f32_16x16x32_bf16 v[64:67], v[28:31], v[124:127], v[64:67]
    ds_read_b128 v[24:27], v4 offset:4096
    v_exp_f32 v109, v109
    v_mfma_f32_16x16x32_bf16 v[68:71], v[28:31], v[140:143], v[68:71]
    v_add_f32 v13, v13, v101
    v_exp_f32 v102, v102
    v_mfma_f32_16x16x32_bf16 v[72:75], v[28:31], v[156:159], v[72:75]
    v_add_f32 v14, v14, v105
    s_waitcnt lgkmcnt(3)
    v_mfma_f32_16x16x32_bf16 v[76:79], v[32:35], v[112:115], v[40:43]
    ds_read_b64_tr_b16 v[28:29], v5 offset:0
    v_exp_f32 v106, v106
    v_mfma_f32_16x16x32_bf16 v[80:83], v[32:35], v[128:131], v[44:47]
    ds_read_b64_tr_b16 v[30:31], v5 offset:4096
    v_add_f32 v15, v15, v109
    v_exp_f32 v110, v110
    v_mfma_f32_16x16x32_bf16 v[84:87], v[32:35], v[144:147], v[48:51]
    v_add_f32 v13, v13, v102
    s_waitcnt lgkmcnt(4)
    v_mfma_f32_16x16x32_bf16 v[76:79], v[16:19], v[116:119], v[76:79]
    ds_read_b64_tr_b16 v[36:37], v6 offset:128
    v_exp_f32 v103, v103
    v_mfma_f32_16x16x32_bf16 v[80:83], v[16:19], v[132:135], v[80:83]
    ds_read_b64_tr_b16 v[38:39], v6 offset:4224
    v_add_f32 v14, v14, v106
    v_mfma_f32_16x16x32_bf16 v[84:87], v[16:19], v[148:151], v[84:87]
    v_exp_f32 v107, v107
    v_add_f32 v15, v15, v110
    s_waitcnt lgkmcnt(5)
    v_mfma_f32_16x16x32_bf16 v[76:79], v[20:23], v[120:123], v[76:79]
    ds_read_b64_tr_b16 v[16:17], v5 offset:256
    v_exp_f32 v111, v111
    v_mfma_f32_16x16x32_bf16 v[80:83], v[20:23], v[136:139], v[80:83]
    ds_read_b64_tr_b16 v[18:19], v5 offset:4352
    v_add_f32 v13, v13, v103
    v_mfma_f32_16x16x32_bf16 v[84:87], v[20:23], v[152:155], v[84:87]
    v_add_f32 v14, v14, v107
    v_add_f32 v15, v15, v111
    s_waitcnt lgkmcnt(6)
    v_mfma_f32_16x16x32_bf16 v[76:79], v[24:27], v[124:127], v[76:79]
    ds_read_b64_tr_b16 v[20:21], v6 offset:384
    v_cvt_pk_bf16_f32 v54, v100, v101
    v_cvt_pk_bf16_f32 v55, v102, v103
    v_mfma_f32_16x16x32_bf16 v[80:83], v[24:27], v[140:143], v[80:83]
    ds_read_b64_tr_b16 v[22:23], v6 offset:4480
    v_cvt_pk_bf16_f32 v58, v104, v105
    v_mfma_f32_16x16x32_bf16 v[84:87], v[24:27], v[156:159], v[84:87]
    v_cvt_pk_bf16_f32 v59, v106, v107
    v_cvt_pk_bf16_f32 v62, v108, v109
    v_cvt_pk_bf16_f32 v63, v110, v111
    s_waitcnt vmcnt(0)
    s_barrier
    s_waitcnt lgkmcnt(6)
    v_mfma_f32_16x16x32_bf16 a[0:3], v[28:31], v[52:55], a[0:3]
    ds_read_b64_tr_b16 v[24:25], v5 offset:512
    s_add_u32 s42, s42, 8192
    s_cmp_eq_u32 s42, 24576
    s_cselect_b32 s40, s12, s79
    s_cselect_b32 s42, 0, s42
    v_mfma_f32_16x16x32_bf16 a[4:7], v[28:31], v[56:59], a[4:7]
    ds_read_b64_tr_b16 v[26:27], v5 offset:4608
    s_add_u32 s15, s19, s13
    s_and_b32 s15, s15, 15
    s_lshl_b32 s15, s15, 13
    s_cmp_lt_u32 s19, 16
    s_cselect_b32 s15, s15, 2130706432
    s_add_u32 s19, s19, 1
    s_add_u32 m0, s77, s17
    v_add_u32 v1, s40, v1
    v_mfma_f32_16x16x32_bf16 a[8:11], v[28:31], v[60:63], a[8:11]
    buffer_load_dwordx4 v9, s[32:35], s15 offen nt lds
    v_add_u32 v2, s40, v2
    s_waitcnt lgkmcnt(6)
    v_mfma_f32_16x16x32_bf16 a[12:15], v[36:39], v[52:55], a[12:15]
    ds_read_b64_tr_b16 v[28:29], v6 offset:640
    v_add_u32 v3, s40, v3
    v_mfma_f32_16x16x32_bf16 a[16:19], v[36:39], v[56:59], a[16:19]
    ds_read_b64_tr_b16 v[30:31], v6 offset:4736
    v_add_u32 v4, s40, v4
    v_exp_f32 v64, v64
    v_mfma_f32_16x16x32_bf16 a[20:23], v[36:39], v[60:63], a[20:23]
    v_exp_f32 v68, v68
    s_waitcnt lgkmcnt(6)
    v_mfma_f32_16x16x32_bf16 a[24:27], v[16:19], v[52:55], a[24:27]
    ds_read_b64_tr_b16 v[32:33], v5 offset:768
    s_add_u32 m0, s77, s17
    s_add_u32 m0, m0, 1024
    s_add_u32 s17, s17, 8192
    s_cmp_eq_u32 s17, 24576
    s_cselect_b32 s17, 0, s17
    v_mfma_f32_16x16x32_bf16 a[28:31], v[16:19], v[56:59], a[28:31]
    ds_read_b64_tr_b16 v[34:35], v5 offset:4864
    buffer_load_dwordx4 v10, s[32:35], s15 offen nt lds
    v_mfma_f32_16x16x32_bf16 a[32:35], v[16:19], v[60:63], a[32:35]
    v_exp_f32 v72, v72
    v_add_f32 v13, v13, v64
    s_waitcnt lgkmcnt(6)
    v_mfma_f32_16x16x32_bf16 a[36:39], v[20:23], v[52:55], a[36:39]
    ds_read_b64_tr_b16 v[36:37], v6 offset:896
    v_exp_f32 v65, v65
    v_add_f32 v14, v14, v68
    v_mfma_f32_16x16x32_bf16 a[40:43], v[20:23], v[56:59], a[40:43]
    ds_read_b64_tr_b16 v[38:39], v6 offset:4992
    v_exp_f32 v69, v69
    v_mfma_f32_16x16x32_bf16 a[44:47], v[20:23], v[60:63], a[44:47]
    s_add_u32 s14, s18, s13
    s_and_b32 s14, s14, 15
    s_lshl_b32 s14, s14, 13
    s_cmp_lt_u32 s18, 16
    s_cselect_b32 s14, s14, 2130706432
    s_add_u32 s18, s18, 1
    s_add_u32 m0, s76, s16
    s_waitcnt lgkmcnt(6)
    v_mfma_f32_16x16x32_bf16 a[48:51], v[24:27], v[52:55], a[48:51]
    ds_read_b128 v[16:19], v1 offset:0
    buffer_load_dwordx4 v7, s[28:31], s14 offen nt lds
    v_add_f32 v15, v15, v72
    v_mfma_f32_16x16x32_bf16 a[52:55], v[24:27], v[56:59], a[52:55]
    v_exp_f32 v73, v73
    v_add_f32 v13, v13, v65
    v_mfma_f32_16x16x32_bf16 a[56:59], v[24:27], v[60:63], a[56:59]
    v_exp_f32 v66, v66
    v_add_f32 v14, v14, v69
    s_waitcnt lgkmcnt(5)
    v_mfma_f32_16x16x32_bf16 a[60:63], v[28:31], v[52:55], a[60:63]
    ds_read_b128 v[20:23], v2 offset:0
    v_exp_f32 v70, v70
    v_mfma_f32_16x16x32_bf16 a[64:67], v[28:31], v[56:59], a[64:67]
    s_add_u32 m0, s76, s16
    s_add_u32 m0, m0, 1024
    s_add_u32 s16, s16, 8192
    s_cmp_eq_u32 s16, 24576
    s_cselect_b32 s16, 0, s16
    v_add_f32 v15, v15, v73
    v_mfma_f32_16x16x32_bf16 a[68:71], v[28:31], v[60:63], a[68:71]
    buffer_load_dwordx4 v8, s[28:31], s14 offen nt lds
    v_exp_f32 v74, v74
    s_waitcnt lgkmcnt(4)
    v_mfma_f32_16x16x32_bf16 a[72:75], v[32:35], v[52:55], a[72:75]
    ds_read_b128 v[24:27], v3 offset:0
    s_add_u32 s43, s43, 8192
    s_cmp_eq_u32 s43, 24576
    s_cselect_b32 s40, s12, s79
    s_cselect_b32 s43, 0, s43
    v_mfma_f32_16x16x32_bf16 a[76:79], v[32:35], v[56:59], a[76:79]
    v_add_u32 v5, s40, v5
    v_add_f32 v13, v13, v66
    v_mfma_f32_16x16x32_bf16 a[80:83], v[32:35], v[60:63], a[80:83]
    v_add_u32 v6, s40, v6
    v_exp_f32 v67, v67
    s_waitcnt lgkmcnt(3)
    v_mfma_f32_16x16x32_bf16 a[84:87], v[36:39], v[52:55], a[84:87]
    ds_read_b128 v[28:31], v4 offset:0
    v_add_f32 v14, v14, v70
    v_exp_f32 v71, v71
    v_mfma_f32_16x16x32_bf16 a[88:91], v[36:39], v[56:59], a[88:91]
    v_add_f32 v15, v15, v74
    v_exp_f32 v75, v75
    v_mfma_f32_16x16x32_bf16 a[92:95], v[36:39], v[60:63], a[92:95]
    v_add_f32 v13, v13, v67
    v_add_f32 v14, v14, v71
    v_add_f32 v15, v15, v75
    s_add_u32 s72, s72, 1
    s_branch L_att_loop
L_att_tail:
    s_waitcnt vmcnt(0)
    s_barrier
    s_lshl_b32 s40, s11, 2
    v_mov_b32 v11, s40
    global_load_dword v12, v11, s[62:63] sc1
    s_mul_i32 s40, s74, 20480
    s_mov_b32 s41, 3277
    v_lshrrev_b32 v45, 4, v0
    v_add_u32 v46, 0, v45
    v_mul_lo_u32 v47, v46, s41
    v_lshrrev_b32 v47, 16, v47
    v_mul_u32_u24 v48, 20, v47
    v_sub_u32 v46, v46, v48
    v_bfe_u32 v48, v47, 2, 1
    v_lshlrev_b32 v48, 1, v48
    v_xor_b32 v46, v46, v48
    v_lshlrev_b32 v46, 4, v46
    v_mul_u32_u24 v47, 1280, v47
    v_add_u32 v46, v46, v47
    v_add_u32 v40, s40, v46
    v_add_u32 v46, 64, v45
    v_mul_lo_u32 v47, v46, s41
    v_lshrrev_b32 v47, 16, v47
    v_mul_u32_u24 v48, 20, v47
    v_sub_u32 v46, v46, v48
    v_bfe_u32 v48, v47, 2, 1
    v_lshlrev_b32 v48, 1, v48
    v_xor_b32 v46, v46, v48
    v_lshlrev_b32 v46, 4, v46
    v_mul_u32_u24 v47, 1280, v47
    v_add_u32 v46, v46, v47
    v_add_u32 v41, s40, v46
    v_add_u32 v46, 128, v45
    v_mul_lo_u32 v47, v46, s41
    v_lshrrev_b32 v47, 16, v47
    v_mul_u32_u24 v48, 20, v47
    v_sub_u32 v46, v46, v48
    v_bfe_u32 v48, v47, 2, 1
    v_lshlrev_b32 v48, 1, v48
    v_xor_b32 v46, v46, v48
    v_lshlrev_b32 v46, 4, v46
    v_mul_u32_u24 v47, 1280, v47
    v_add_u32 v46, v46, v47
    v_add_u32 v42, s40, v46
    v_add_u32 v46, 192, v45
    v_mul_lo_u32 v47, v46, s41
    v_lshrrev_b32 v47, 16, v47
    v_mul_u32_u24 v48, 20, v47
    v_sub_u32 v46, v46, v48
    v_bfe_u32 v48, v47, 2, 1
    v_lshlrev_b32 v48, 1, v48
    v_xor_b32 v46, v46, v48
    v_lshlrev_b32 v46, 4, v46
    v_mul_u32_u24 v47, 1280, v47
    v_add_u32 v46, v46, v47
    v_add_u32 v43, s40, v46
    v_add_u32 v46, 256, v45
    v_mul_lo_u32 v47, v46, s41
    v_lshrrev_b32 v47, 16, v47
    v_mul_u32_u24 v48, 20, v47
    v_sub_u32 v46, v46, v48
    v_bfe_u32 v48, v47, 2, 1
    v_lshlrev_b32 v48, 1, v48
    v_xor_b32 v46, v46, v48
    v_lshlrev_b32 v46, 4, v46
    v_mul_u32_u24 v47, 1280, v47
    v_add_u32 v46, v46, v47
    v_add_u32 v44, s40, v46
    s_mul_i32 s40, s8, 1310720
    s_mul_i32 s41, s10, 320
    s_add_u32 s40, s40, s41
    s_add_u32 s20, s58, s40
    s_addc_u32 s21, s59, 0
    s_sub_u32 s22, 1310720, s41
    s_mov_b32 s23, 0x20000
    s_lshl_b32 s12, s10, 1
    s_add_u32 s13, s12, s4
    s_mul_i32 s44, s13, 163840
    s_mul_i32 s14, s4, 3
    s_add_u32 s15, s14, 0
    s_add_u32 s16, s15, 2
    s_cmp_lt_u32 s15, s12
    s_cselect_b32 s15, s15, s16
    s_mul_i32 s45, s15, 163840
    s_mul_i32 s49, s15, 49152
    s_add_u32 s15, s14, 1
    s_add_u32 s16, s15, 2
    s_cmp_lt_u32 s15, s12
    s_cselect_b32 s15, s15, s16
    s_mul_i32 s46, s15, 163840
    s_mul_i32 s50, s15, 49152
    s_add_u32 s15, s14, 2
    s_add_u32 s16, s15, 2
    s_cmp_lt_u32 s15, s12
    s_cselect_b32 s15, s15, s16
    s_mul_i32 s47, s15, 163840
    s_mul_i32 s51, s15, 49152
    s_mul_i32 s64, s74, 5120
    s_add_u32 s64, s64, s75
    s_mov_b32 s78, s64
    s_add_u32 s17, s64, 40960
    s_add_u32 s70, s44, 81920
    s_add_u32 s71, s45, 81920
    ds_read_b64_tr_b16 v[28:29], v5 offset:0
    ds_read_b64_tr_b16 v[30:31], v5 offset:4096
    ds_read_b64_tr_b16 v[36:37], v6 offset:128
    ds_read_b64_tr_b16 v[38:39], v6 offset:4224
    ds_read_b64_tr_b16 v[16:17], v5 offset:256
    ds_read_b64_tr_b16 v[18:19], v5 offset:4352
    ds_read_b64_tr_b16 v[20:21], v6 offset:384
    ds_read_b64_tr_b16 v[22:23], v6 offset:4480
    v_cvt_pk_bf16_f32 v52, v88, v89
    v_cvt_pk_bf16_f32 v53, v90, v91
    v_cvt_pk_bf16_f32 v56, v92, v93
    v_cvt_pk_bf16_f32 v57, v94, v95
    v_cvt_pk_bf16_f32 v60, v96, v97
    v_cvt_pk_bf16_f32 v61, v98, v99
    v_exp_f32 v100, v100
    v_exp_f32 v104, v104
    v_exp_f32 v108, v108
    v_add_f32 v13, v13, v100
    v_exp_f32 v101, v101
    v_add_f32 v14, v14, v104
    v_exp_f32 v105, v105
    v_add_f32 v15, v15, v108
    v_exp_f32 v109, v109
    v_add_f32 v13, v13, v101
    v_exp_f32 v102, v102
    v_add_f32 v14, v14, v105
    v_exp_f32 v106, v106
    v_add_f32 v15, v15, v109
    v_exp_f32 v110, v110
    v_add_f32 v13, v13, v102
    v_exp_f32 v103, v103
    v_add_f32 v14, v14, v106
    v_exp_f32 v107, v107
    v_add_f32 v15, v15, v110
    v_exp_f32 v111, v111
    v_add_f32 v13, v13, v103
    v_add_f32 v14, v14, v107
    v_add_f32 v15, v15, v111
    v_cvt_pk_bf16_f32 v54, v100, v101
    v_cvt_pk_bf16_f32 v55, v102, v103
    v_cvt_pk_bf16_f32 v58, v104, v105
    v_cvt_pk_bf16_f32 v59, v106, v107
    v_cvt_pk_bf16_f32 v62, v108, v109
    v_cvt_pk_bf16_f32 v63, v110, v111
    s_waitcnt lgkmcnt(6)
    v_mfma_f32_16x16x32_bf16 a[0:3], v[28:31], v[52:55], a[0:3]
    ds_read_b64_tr_b16 v[24:25], v5 offset:512
    s_add_u32 m0, s78, 0
    v_mfma_f32_16x16x32_bf16 a[4:7], v[28:31], v[56:59], a[4:7]
    ds_read_b64_tr_b16 v[26:27], v5 offset:4608
    buffer_load_dwordx4 v40, s[20:23], s44 offen lds
    v_mfma_f32_16x16x32_bf16 a[8:11], v[28:31], v[60:63], a[8:11]
    s_add_u32 m0, s78, 1024
    s_waitcnt lgkmcnt(6)
    v_mfma_f32_16x16x32_bf16 a[12:15], v[36:39], v[52:55], a[12:15]
    ds_read_b64_tr_b16 v[28:29], v6 offset:640
    buffer_load_dwordx4 v41, s[20:23], s44 offen lds
    v_mfma_f32_16x16x32_bf16 a[16:19], v[36:39], v[56:59], a[16:19]
    ds_read_b64_tr_b16 v[30:31], v6 offset:4736
    s_add_u32 m0, s78, 2048
    v_mfma_f32_16x16x32_bf16 a[20:23], v[36:39], v[60:63], a[20:23]
    buffer_load_dwordx4 v42, s[20:23], s44 offen lds
    s_waitcnt lgkmcnt(6)
    v_mfma_f32_16x16x32_bf16 a[24:27], v[16:19], v[52:55], a[24:27]
    ds_read_b64_tr_b16 v[32:33], v5 offset:768
    s_add_u32 m0, s78, 3072
    v_mfma_f32_16x16x32_bf16 a[28:31], v[16:19], v[56:59], a[28:31]
    ds_read_b64_tr_b16 v[34:35], v5 offset:4864
    buffer_load_dwordx4 v43, s[20:23], s44 offen lds
    v_mfma_f32_16x16x32_bf16 a[32:35], v[16:19], v[60:63], a[32:35]
    s_add_u32 m0, s78, 4096
    s_waitcnt lgkmcnt(6)
    v_mfma_f32_16x16x32_bf16 a[36:39], v[20:23], v[52:55], a[36:39]
    ds_read_b64_tr_b16 v[36:37], v6 offset:896
    buffer_load_dwordx4 v44, s[20:23], s44 offen lds
    v_mfma_f32_16x16x32_bf16 a[40:43], v[20:23], v[56:59], a[40:43]
    ds_read_b64_tr_b16 v[38:39], v6 offset:4992
    s_add_u32 m0, s78, 20480
    v_mfma_f32_16x16x32_bf16 a[44:47], v[20:23], v[60:63], a[44:47]
    buffer_load_dwordx4 v40, s[20:23], s70 offen lds
    s_waitcnt lgkmcnt(6)
    v_mfma_f32_16x16x32_bf16 a[48:51], v[24:27], v[52:55], a[48:51]
    s_add_u32 m0, s78, 21504
    v_mfma_f32_16x16x32_bf16 a[52:55], v[24:27], v[56:59], a[52:55]
    buffer_load_dwordx4 v41, s[20:23], s70 offen lds
    v_mfma_f32_16x16x32_bf16 a[56:59], v[24:27], v[60:63], a[56:59]
    s_add_u32 m0, s78, 22528
    s_waitcnt lgkmcnt(4)
    v_mfma_f32_16x16x32_bf16 a[60:63], v[28:31], v[52:55], a[60:63]
    buffer_load_dwordx4 v42, s[20:23], s70 offen lds
    v_mfma_f32_16x16x32_bf16 a[64:67], v[28:31], v[56:59], a[64:67]
    s_add_u32 m0, s78, 23552
    v_mfma_f32_16x16x32_bf16 a[68:71], v[28:31], v[60:63], a[68:71]
    buffer_load_dwordx4 v43, s[20:23], s70 offen lds
    s_waitcnt lgkmcnt(2)
    v_mfma_f32_16x16x32_bf16 a[72:75], v[32:35], v[52:55], a[72:75]
    s_add_u32 m0, s78, 24576
    v_mfma_f32_16x16x32_bf16 a[76:79], v[32:35], v[56:59], a[76:79]
    buffer_load_dwordx4 v44, s[20:23], s70 offen lds
    v_mfma_f32_16x16x32_bf16 a[80:83], v[32:35], v[60:63], a[80:83]
    s_waitcnt lgkmcnt(0)
    v_mfma_f32_16x16x32_bf16 a[84:87], v[36:39], v[52:55], a[84:87]
    v_mfma_f32_16x16x32_bf16 a[88:91], v[36:39], v[56:59], a[88:91]
    v_mfma_f32_16x16x32_bf16 a[92:95], v[36:39], v[60:63], a[92:95]
    v_mov_b32 v52, v13
    v_mov_b32 v53, v14
    v_mov_b32 v54, v15
    v_permlane16_swap_b32 v13, v52
    v_permlane16_swap_b32 v14, v53
    v_permlane16_swap_b32 v15, v54
    v_add_f32 v13, v13, v52
    v_add_f32 v14, v14, v53
    v_add_f32 v15, v15, v54
    v_mov_b32 v52, v13
    v_mov_b32 v53, v14
    v_mov_b32 v54, v15
    v_permlane32_swap_b32 v13, v52
    v_permlane32_swap_b32 v14, v53
    v_permlane32_swap_b32 v15, v54
    v_add_f32 v13, v13, v52
    v_add_f32 v14, v14, v53
    v_add_f32 v15, v15, v54
    s_mov_b32 s40, 1400897536
    v_max3_f32 v52, v13, v14, v15
    v_add_f32 v53, v13, v14
    v_add_f32 v53, v53, v15
    v_mov_b32 v54, s40
    v_cmp_nle_f32 vcc, v53, v54
    s_nop 2
    s_cmp_lg_u64 vcc, 0
    s_cselect_b32 s41, 1, 0
    s_lshl_b32 s40, s3, 2
    s_add_u32 s40, s40, 57344
    v_mov_b32 v52, s40
    v_mov_b32 v53, s41
    ds_write_b32 v52, v53
    s_waitcnt lgkmcnt(0)
    s_barrier
    v_mov_b32 v52, 57344
    ds_read_b128 v[56:59], v52
    ds_read_b128 v[60:63], v52 offset:16
    s_waitcnt lgkmcnt(0)
    v_or_b32 v56, v56, v57
    v_or_b32 v56, v56, v58
    v_or_b32 v56, v56, v59
    v_or_b32 v56, v56, v60
    v_or_b32 v56, v56, v61
    v_or_b32 v56, v56, v62
    v_or_b32 v56, v56, v63
    s_nop 0
    v_readfirstlane_b32 s41, v56
    s_nop 2
    s_andn2_b32 s41, s41, s73
    s_cmp_lg_u32 s41, 0
    s_cbranch_scc1 L_slow
    s_waitcnt vmcnt(10)
    v_readfirstlane_b32 s40, v12
    s_nop 2
    s_and_b32 s40, s40, 0xffff
    s_mul_i32 s41, s5, s5
    s_lshl_b32 s41, s41, 10
    s_lshl_b32 s42, s5, 5
    s_add_u32 s41, s41, s42
    s_add_u32 s41, s41, 4
    s_cmp_eq_u32 s40, s41
    s_cselect_b32 s9, 1, 0
    v_mov_b32 v144, v40
    v_mov_b32 v145, v41
    v_mov_b32 v146, v42
    v_mov_b32 v147, v43
    v_mov_b32 v148, v44
    v_lshrrev_b32 v64, 4, v0
    v_and_b32 v65, 15, v64
    v_lshrrev_b32 v66, 4, v64
    v_lshrrev_b32 v67, 2, v65
    v_and_b32 v68, 3, v65
    v_lshl_add_u32 v69, v66, 2, v67
    v_mul_u32_u24 v69, 320, v69
    v_lshl_add_u32 v69, v68, 3, v69
    v_add_u32 v69, s75, v69
    v_and_b32 v67, 1, v66
    v_lshlrev_b32 v67, 5, v67
    v_add_u32 v104, v69, v67
    v_sub_u32 v105, v69, v67
    v_add_u32 v111, 40960, v104
    v_add_u32 v112, 40960, v105
    v_add_u32 v133, 4096, v0
    v_add_u32 v134, 8192, v0
    v_rcp_f32 v13, v13
    v_rcp_f32 v14, v14
    v_rcp_f32 v15, v15
    v_mov_b32 v136, v13
    v_mov_b32 v137, v13
    v_mov_b32 v138, v14
    v_mov_b32 v139, v14
    v_mov_b32 v140, v15
    v_mov_b32 v141, v15
    v_accvgpr_read_b32 v64, a0
    v_accvgpr_read_b32 v65, a1
    v_accvgpr_read_b32 v66, a2
    v_accvgpr_read_b32 v67, a3
    v_accvgpr_read_b32 v68, a12
    v_accvgpr_read_b32 v69, a13
    v_accvgpr_read_b32 v70, a14
    v_accvgpr_read_b32 v71, a15
    v_pk_mul_f32 v[64:65], v[64:65], v[136:137]
    v_pk_mul_f32 v[66:67], v[66:67], v[136:137]
    v_pk_mul_f32 v[68:69], v[68:69], v[136:137]
    v_pk_mul_f32 v[70:71], v[70:71], v[136:137]
    v_cvt_pk_bf16_f32 v16, v64, v65
    v_cvt_pk_bf16_f32 v17, v66, v67
    v_cvt_pk_bf16_f32 v18, v68, v69
    v_cvt_pk_bf16_f32 v19, v70, v71
    v_accvgpr_read_b32 v72, a4
    v_accvgpr_read_b32 v73, a5
    v_accvgpr_read_b32 v74, a6
    v_accvgpr_read_b32 v75, a7
    v_accvgpr_read_b32 v76, a16
    v_accvgpr_read_b32 v77, a17
    v_accvgpr_read_b32 v78, a18
    v_accvgpr_read_b32 v79, a19
    v_pk_mul_f32 v[72:73], v[72:73], v[138:139]
    v_pk_mul_f32 v[74:75], v[74:75], v[138:139]
    v_pk_mul_f32 v[76:77], v[76:77], v[138:139]
    v_pk_mul_f32 v[78:79], v[78:79], v[138:139]
    v_cvt_pk_bf16_f32 v20, v72, v73
    v_cvt_pk_bf16_f32 v21, v74, v75
    v_cvt_pk_bf16_f32 v22, v76, v77
    v_cvt_pk_bf16_f32 v23, v78, v79
    v_accvgpr_read_b32 v64, a8
    v_accvgpr_read_b32 v65, a9
    v_accvgpr_read_b32 v66, a10
    v_accvgpr_read_b32 v67, a11
    v_accvgpr_read_b32 v68, a20
    v_accvgpr_read_b32 v69, a21
    v_accvgpr_read_b32 v70, a22
    v_accvgpr_read_b32 v71, a23
    v_pk_mul_f32 v[64:65], v[64:65], v[140:141]
    v_pk_mul_f32 v[66:67], v[66:67], v[140:141]
    v_pk_mul_f32 v[68:69], v[68:69], v[140:141]
    v_pk_mul_f32 v[70:71], v[70:71], v[140:141]
    v_cvt_pk_bf16_f32 v24, v64, v65
    v_cvt_pk_bf16_f32 v25, v66, v67
    v_cvt_pk_bf16_f32 v26, v68, v69
    v_cvt_pk_bf16_f32 v27, v70, v71
    v_accvgpr_read_b32 v72, a24
    v_accvgpr_read_b32 v73, a25
    v_accvgpr_read_b32 v74, a26
    v_accvgpr_read_b32 v75, a27
    v_accvgpr_read_b32 v76, a36
    v_accvgpr_read_b32 v77, a37
    v_accvgpr_read_b32 v78, a38
    v_accvgpr_read_b32 v79, a39
    v_pk_mul_f32 v[72:73], v[72:73], v[136:137]
    v_pk_mul_f32 v[74:75], v[74:75], v[136:137]
    v_pk_mul_f32 v[76:77], v[76:77], v[136:137]
    v_pk_mul_f32 v[78:79], v[78:79], v[136:137]
    v_cvt_pk_bf16_f32 v28, v72, v73
    v_cvt_pk_bf16_f32 v29, v74, v75
    v_cvt_pk_bf16_f32 v30, v76, v77
    v_cvt_pk_bf16_f32 v31, v78, v79
    v_accvgpr_read_b32 v64, a28
    v_accvgpr_read_b32 v65, a29
    v_accvgpr_read_b32 v66, a30
    v_accvgpr_read_b32 v67, a31
    v_accvgpr_read_b32 v68, a40
    v_accvgpr_read_b32 v69, a41
    v_accvgpr_read_b32 v70, a42
    v_accvgpr_read_b32 v71, a43
    v_pk_mul_f32 v[64:65], v[64:65], v[138:139]
    v_pk_mul_f32 v[66:67], v[66:67], v[138:139]
    v_pk_mul_f32 v[68:69], v[68:69], v[138:139]
    v_pk_mul_f32 v[70:71], v[70:71], v[138:139]
    v_cvt_pk_bf16_f32 v32, v64, v65
    v_cvt_pk_bf16_f32 v33, v66, v67
    v_cvt_pk_bf16_f32 v34, v68, v69
    v_cvt_pk_bf16_f32 v35, v70, v71
    v_accvgpr_read_b32 v72, a32
    v_accvgpr_read_b32 v73, a33
    v_accvgpr_read_b32 v74, a34
    v_accvgpr_read_b32 v75, a35
    v_accvgpr_read_b32 v76, a44
    v_accvgpr_read_b32 v77, a45
    v_accvgpr_read_b32 v78, a46
    v_accvgpr_read_b32 v79, a47
    v_pk_mul_f32 v[72:73], v[72:73], v[140:141]
    v_pk_mul_f32 v[74:75], v[74:75], v[140:141]
    v_pk_mul_f32 v[76:77], v[76:77], v[140:141]
    v_pk_mul_f32 v[78:79], v[78:79], v[140:141]
    v_cvt_pk_bf16_f32 v36, v72, v73
    v_cvt_pk_bf16_f32 v37, v74, v75
    v_cvt_pk_bf16_f32 v38, v76, v77
    v_cvt_pk_bf16_f32 v39, v78, v79
    v_accvgpr_read_b32 v64, a48
    v_accvgpr_read_b32 v65, a49
    v_accvgpr_read_b32 v66, a50
    v_accvgpr_read_b32 v67, a51
    v_accvgpr_read_b32 v68, a60
    v_accvgpr_read_b32 v69, a61
    v_accvgpr_read_b32 v70, a62
    v_accvgpr_read_b32 v71, a63
    v_pk_mul_f32 v[64:65], v[64:65], v[136:137]
    v_pk_mul_f32 v[66:67], v[66:67], v[136:137]
    v_pk_mul_f32 v[68:69], v[68:69], v[136:137]
    v_pk_mul_f32 v[70:71], v[70:71], v[136:137]
    v_cvt_pk_bf16_f32 v40, v64, v65
    v_cvt_pk_bf16_f32 v41, v66, v67
    v_cvt_pk_bf16_f32 v42, v68, v69
    v_cvt_pk_bf16_f32 v43, v70, v71
    v_accvgpr_read_b32 v72, a52
    v_accvgpr_read_b32 v73, a53
    v_accvgpr_read_b32 v74, a54
    v_accvgpr_read_b32 v75, a55
    v_accvgpr_read_b32 v76, a64
    v_accvgpr_read_b32 v77, a65
    v_accvgpr_read_b32 v78, a66
    v_accvgpr_read_b32 v79, a67
    v_pk_mul_f32 v[72:73], v[72:73], v[138:139]
    v_pk_mul_f32 v[74:75], v[74:75], v[138:139]
    v_pk_mul_f32 v[76:77], v[76:77], v[138:139]
    v_pk_mul_f32 v[78:79], v[78:79], v[138:139]
    v_cvt_pk_bf16_f32 v44, v72, v73
    v_cvt_pk_bf16_f32 v45, v74, v75
    v_cvt_pk_bf16_f32 v46, v76, v77
    v_cvt_pk_bf16_f32 v47, v78, v79
    v_accvgpr_read_b32 v64, a56
    v_accvgpr_read_b32 v65, a57
    v_accvgpr_read_b32 v66, a58
    v_accvgpr_read_b32 v67, a59
    v_accvgpr_read_b32 v68, a68
    v_accvgpr_read_b32 v69, a69
    v_accvgpr_read_b32 v70, a70
    v_accvgpr_read_b32 v71, a71
    v_pk_mul_f32 v[64:65], v[64:65], v[140:141]
    v_pk_mul_f32 v[66:67], v[66:67], v[140:141]
    v_pk_mul_f32 v[68:69], v[68:69], v[140:141]
    v_pk_mul_f32 v[70:71], v[70:71], v[140:141]
    v_cvt_pk_bf16_f32 v48, v64, v65
    v_cvt_pk_bf16_f32 v49, v66, v67
    v_cvt_pk_bf16_f32 v50, v68, v69
    v_cvt_pk_bf16_f32 v51, v70, v71
    v_accvgpr_read_b32 v72, a72
    v_accvgpr_read_b32 v73, a73
    v_accvgpr_read_b32 v74, a74
    v_accvgpr_read_b32 v75, a75
    v_accvgpr_read_b32 v76, a84
    v_accvgpr_read_b32 v77, a85
    v_accvgpr_read_b32 v78, a86
    v_accvgpr_read_b32 v79, a87
    v_pk_mul_f32 v[72:73], v[72:73], v[136:137]
    v_pk_mul_f32 v[74:75], v[74:75], v[136:137]
    v_pk_mul_f32 v[76:77], v[76:77], v[136:137]
    v_pk_mul_f32 v[78:79], v[78:79], v[136:137]
    v_cvt_pk_bf16_f32 v52, v72, v73
    v_cvt_pk_bf16_f32 v53, v74, v75
    v_cvt_pk_bf16_f32 v54, v76, v77
    v_cvt_pk_bf16_f32 v55, v78, v79
    v_accvgpr_read_b32 v64, a76
    v_accvgpr_read_b32 v65, a77
    v_accvgpr_read_b32 v66, a78
    v_accvgpr_read_b32 v67, a79
    v_accvgpr_read_b32 v68, a88
    v_accvgpr_read_b32 v69, a89
    v_accvgpr_read_b32 v70, a90
    v_accvgpr_read_b32 v71, a91
    v_pk_mul_f32 v[64:65], v[64:65], v[138:139]
    v_pk_mul_f32 v[66:67], v[66:67], v[138:139]
    v_pk_mul_f32 v[68:69], v[68:69], v[138:139]
    v_pk_mul_f32 v[70:71], v[70:71], v[138:139]
    v_cvt_pk_bf16_f32 v56, v64, v65
    v_cvt_pk_bf16_f32 v57, v66, v67
    v_cvt_pk_bf16_f32 v58, v68, v69
    v_cvt_pk_bf16_f32 v59, v70, v71
    v_accvgpr_read_b32 v72, a80
    v_accvgpr_read_b32 v73, a81
    v_accvgpr_read_b32 v74, a82
    v_accvgpr_read_b32 v75, a83
    v_accvgpr_read_b32 v76, a92
    v_accvgpr_read_b32 v77, a93
    v_accvgpr_read_b32 v78, a94
    v_accvgpr_read_b32 v79, a95
    v_pk_mul_f32 v[72:73], v[72:73], v[140:141]
    v_pk_mul_f32 v[74:75], v[74:75], v[140:141]
    v_pk_mul_f32 v[76:77], v[76:77], v[140:141]
    v_pk_mul_f32 v[78:79], v[78:79], v[140:141]
    v_cvt_pk_bf16_f32 v60, v72, v73
    v_cvt_pk_bf16_f32 v61, v74, v75
    v_cvt_pk_bf16_f32 v62, v76, v77
    v_cvt_pk_bf16_f32 v63, v78, v79
    s_mov_b32 s76, 4096
    s_mov_b32 s77, 8192
    s_cmp_eq_u32 s9, 1
    s_branch L_ostore_sc1
    s_cbranch_scc0 L_ostore_sc1
    buffer_store_dwordx4 v[16:19], v0, s[36:39], 0 offen offset:0
    buffer_store_dwordx4 v[20:23], v0, s[36:39], s76 offen offset:0
    buffer_store_dwordx4 v[24:27], v0, s[36:39], s77 offen offset:0
    buffer_store_dwordx4 v[28:31], v0, s[36:39], 0 offen offset:1024
    buffer_store_dwordx4 v[32:35], v0, s[36:39], s76 offen offset:1024
    buffer_store_dwordx4 v[36:39], v0, s[36:39], s77 offen offset:1024
    buffer_store_dwordx4 v[40:43], v0, s[36:39], 0 offen offset:2048
    buffer_store_dwordx4 v[44:47], v0, s[36:39], s76 offen offset:2048
    buffer_store_dwordx4 v[48:51], v0, s[36:39], s77 offen offset:2048
    buffer_store_dwordx4 v[52:55], v0, s[36:39], 0 offen offset:3072
    buffer_store_dwordx4 v[56:59], v0, s[36:39], s76 offen offset:3072
    buffer_store_dwordx4 v[60:63], v0, s[36:39], s77 offen offset:3072
    s_branch L_ostore_done
L_ostore_sc1:
    buffer_store_dwordx4 v[16:19], v0, s[36:39], 0 offen offset:0 sc1
    buffer_store_dwordx4 v[20:23], v0, s[36:39], s76 offen offset:0 sc1
    buffer_store_dwordx4 v[24:27], v0, s[36:39], s77 offen offset:0 sc1
    buffer_store_dwordx4 v[28:31], v0, s[36:39], 0 offen offset:1024 sc1
    buffer_store_dwordx4 v[32:35], v0, s[36:39], s76 offen offset:1024 sc1
    buffer_store_dwordx4 v[36:39], v0, s[36:39], s77 offen offset:1024 sc1
    buffer_store_dwordx4 v[40:43], v0, s[36:39], 0 offen offset:2048 sc1
    buffer_store_dwordx4 v[44:47], v0, s[36:39], s76 offen offset:2048 sc1
    buffer_store_dwordx4 v[48:51], v0, s[36:39], s77 offen offset:2048 sc1
    buffer_store_dwordx4 v[52:55], v0, s[36:39], 0 offen offset:3072 sc1
    buffer_store_dwordx4 v[56:59], v0, s[36:39], s76 offen offset:3072 sc1
    buffer_store_dwordx4 v[60:63], v0, s[36:39], s77 offen offset:3072 sc1
L_ostore_done:
    s_lshl_b32 s40, s6, 3
    s_add_u32 s40, s40, s7
    s_lshl_b32 s40, s40, 5
    s_lshl_b32 s41, s8, 3
    s_add_u32 s40, s40, s41
    s_mul_i32 s40, s40, 49152
    s_mul_i32 s41, s74, 12288
    s_add_u32 s40, s40, s41
    s_add_u32 s24, s60, s40
    s_addc_u32 s25, s61, 0
    s_mov_b32 s26, 356352
    s_mov_b32 s27, 0x20000
    s_lshl_b32 s79, s6, 3
    s_add_u32 s79, s79, s7
    s_lshl_b32 s79, s79, 2
    s_add_u32 s79, s79, s10
    s_waitcnt vmcnt(12)
    s_barrier
    ds_read_b64_tr_b16 v[64:65], v104 offset:0
    ds_read_b64_tr_b16 v[66:67], v104 offset:5120
    ds_read_b64_tr_b16 v[68:69], v105 offset:32
    ds_read_b64_tr_b16 v[70:71], v105 offset:5152
    ds_read_b64_tr_b16 v[72:73], v104 offset:64
    ds_read_b64_tr_b16 v[74:75], v104 offset:5184
    ds_read_b64_tr_b16 v[76:77], v105 offset:96
    ds_read_b64_tr_b16 v[78:79], v105 offset:5216
    ds_read_b64_tr_b16 v[116:117], v104 offset:128
    ds_read_b64_tr_b16 v[118:119], v104 offset:5248
    ds_read_b64_tr_b16 v[120:121], v105 offset:160
    ds_read_b64_tr_b16 v[122:123], v105 offset:5280
    s_waitcnt lgkmcnt(10)
    v_mfma_f32_16x16x32_bf16 a[0:3], v[64:67], v[16:19], 0
    ds_read_b64_tr_b16 v[124:125], v104 offset:192
    v_mfma_f32_16x16x32_bf16 a[4:7], v[64:67], v[20:23], 0
    ds_read_b64_tr_b16 v[126:127], v104 offset:5312
    s_add_u32 m0, s17, 0
    v_mfma_f32_16x16x32_bf16 a[8:11], v[64:67], v[24:27], 0
    buffer_load_dwordx4 v144, s[20:23], s45 offen lds
    s_waitcnt lgkmcnt(10)
    v_mfma_f32_16x16x32_bf16 a[12:15], v[68:71], v[16:19], 0
    ds_read_b64_tr_b16 v[128:129], v105 offset:224
    v_mfma_f32_16x16x32_bf16 a[16:19], v[68:71], v[20:23], 0
    ds_read_b64_tr_b16 v[130:131], v105 offset:5344
    v_mfma_f32_16x16x32_bf16 a[20:23], v[68:71], v[24:27], 0
    s_waitcnt lgkmcnt(10)
    v_mfma_f32_16x16x32_bf16 a[24:27], v[72:75], v[16:19], 0
    ds_read_b64_tr_b16 v[64:65], v104 offset:256
    s_add_u32 m0, s17, 1024
    v_mfma_f32_16x16x32_bf16 a[28:31], v[72:75], v[20:23], 0
    ds_read_b64_tr_b16 v[66:67], v104 offset:5376
    buffer_load_dwordx4 v145, s[20:23], s45 offen lds
    v_mfma_f32_16x16x32_bf16 a[32:35], v[72:75], v[24:27], 0
    s_waitcnt lgkmcnt(10)
    v_mfma_f32_16x16x32_bf16 a[36:39], v[76:79], v[16:19], 0
    ds_read_b64_tr_b16 v[68:69], v105 offset:288
    v_mfma_f32_16x16x32_bf16 a[40:43], v[76:79], v[20:23], 0
    ds_read_b64_tr_b16 v[70:71], v105 offset:5408
    v_mfma_f32_16x16x32_bf16 a[44:47], v[76:79], v[24:27], 0
    s_add_u32 m0, s17, 2048
    s_waitcnt lgkmcnt(10)
    v_mfma_f32_16x16x32_bf16 a[48:51], v[116:119], v[16:19], 0
    ds_read_b64_tr_b16 v[72:73], v104 offset:10240
    buffer_load_dwordx4 v146, s[20:23], s45 offen lds
    v_mfma_f32_16x16x32_bf16 a[52:55], v[116:119], v[20:23], 0
    ds_read_b64_tr_b16 v[74:75], v104 offset:15360
    v_mfma_f32_16x16x32_bf16 a[56:59], v[116:119], v[24:27], 0
    s_waitcnt lgkmcnt(10)
    v_mfma_f32_16x16x32_bf16 a[60:63], v[120:123], v[16:19], 0
    ds_read_b64_tr_b16 v[76:77], v105 offset:10272
    v_mfma_f32_16x16x32_bf16 a[64:67], v[120:123], v[20:23], 0
    ds_read_b64_tr_b16 v[78:79], v105 offset:15392
    s_add_u32 m0, s17, 3072
    v_mfma_f32_16x16x32_bf16 a[68:71], v[120:123], v[24:27], 0
    buffer_load_dwordx4 v147, s[20:23], s45 offen lds
    s_waitcnt lgkmcnt(10)
    v_mfma_f32_16x16x32_bf16 a[72:75], v[124:127], v[16:19], 0
    ds_read_b64_tr_b16 v[116:117], v104 offset:10304
    v_mfma_f32_16x16x32_bf16 a[76:79], v[124:127], v[20:23], 0
    ds_read_b64_tr_b16 v[118:119], v104 offset:15424
    v_mfma_f32_16x16x32_bf16 a[80:83], v[124:127], v[24:27], 0
    s_waitcnt lgkmcnt(10)
    v_mfma_f32_16x16x32_bf16 a[84:87], v[128:131], v[16:19], 0
    ds_read_b64_tr_b16 v[120:121], v105 offset:10336
    s_add_u32 m0, s17, 4096
    v_mfma_f32_16x16x32_bf16 a[88:91], v[128:131], v[20:23], 0
    ds_read_b64_tr_b16 v[122:123], v105 offset:15456
    buffer_load_dwordx4 v148, s[20:23], s45 offen lds
    v_mfma_f32_16x16x32_bf16 a[92:95], v[128:131], v[24:27], 0
    s_waitcnt lgkmcnt(10)
    v_mfma_f32_16x16x32_bf16 v[80:83], v[64:67], v[16:19], 0
    ds_read_b64_tr_b16 v[124:125], v104 offset:10368
    v_mfma_f32_16x16x32_bf16 v[84:87], v[64:67], v[20:23], 0
    ds_read_b64_tr_b16 v[126:127], v104 offset:15488
    v_mfma_f32_16x16x32_bf16 v[88:91], v[64:67], v[24:27], 0
    s_waitcnt lgkmcnt(10)
    v_mfma_f32_16x16x32_bf16 v[92:95], v[68:71], v[16:19], 0
    ds_read_b64_tr_b16 v[128:129], v105 offset:10400
    v_mfma_f32_16x16x32_bf16 v[96:99], v[68:71], v[20:23], 0
    ds_read_b64_tr_b16 v[130:131], v105 offset:15520
    v_mfma_f32_16x16x32_bf16 v[100:103], v[68:71], v[24:27], 0
    s_waitcnt lgkmcnt(10)
    v_mfma_f32_16x16x32_bf16 a[0:3], v[72:75], v[28:31], a[0:3]
    ds_read_b64_tr_b16 v[64:65], v104 offset:10432
    v_mfma_f32_16x16x32_bf16 a[4:7], v[72:75], v[32:35], a[4:7]
    ds_read_b64_tr_b16 v[66:67], v104 offset:15552
    s_add_u32 m0, s17, 20480
    v_mfma_f32_16x16x32_bf16 a[8:11], v[72:75], v[36:39], a[8:11]
    buffer_load_dwordx4 v144, s[20:23], s71 offen lds
    s_waitcnt lgkmcnt(10)
    v_mfma_f32_16x16x32_bf16 a[12:15], v[76:79], v[28:31], a[12:15]
    ds_read_b64_tr_b16 v[68:69], v105 offset:10464
    v_mfma_f32_16x16x32_bf16 a[16:19], v[76:79], v[32:35], a[16:19]
    ds_read_b64_tr_b16 v[70:71], v105 offset:15584
    v_mfma_f32_16x16x32_bf16 a[20:23], v[76:79], v[36:39], a[20:23]
    s_waitcnt lgkmcnt(10)
    v_mfma_f32_16x16x32_bf16 a[24:27], v[116:119], v[28:31], a[24:27]
    ds_read_b64_tr_b16 v[72:73], v104 offset:10496
    s_add_u32 m0, s17, 21504
    v_mfma_f32_16x16x32_bf16 a[28:31], v[116:119], v[32:35], a[28:31]
    ds_read_b64_tr_b16 v[74:75], v104 offset:15616
    buffer_load_dwordx4 v145, s[20:23], s71 offen lds
    v_mfma_f32_16x16x32_bf16 a[32:35], v[116:119], v[36:39], a[32:35]
    s_waitcnt lgkmcnt(10)
    v_mfma_f32_16x16x32_bf16 a[36:39], v[120:123], v[28:31], a[36:39]
    ds_read_b64_tr_b16 v[76:77], v105 offset:10528
    v_mfma_f32_16x16x32_bf16 a[40:43], v[120:123], v[32:35], a[40:43]
    ds_read_b64_tr_b16 v[78:79], v105 offset:15648
    v_mfma_f32_16x16x32_bf16 a[44:47], v[120:123], v[36:39], a[44:47]
    s_add_u32 m0, s17, 22528
    s_waitcnt lgkmcnt(10)
    v_mfma_f32_16x16x32_bf16 a[48:51], v[124:127], v[28:31], a[48:51]
    ds_read_b64_tr_b16 v[116:117], v104 offset:20480
    buffer_load_dwordx4 v146, s[20:23], s71 offen lds
    v_mfma_f32_16x16x32_bf16 a[52:55], v[124:127], v[32:35], a[52:55]
    ds_read_b64_tr_b16 v[118:119], v104 offset:25600
    v_mfma_f32_16x16x32_bf16 a[56:59], v[124:127], v[36:39], a[56:59]
    s_waitcnt lgkmcnt(10)
    v_mfma_f32_16x16x32_bf16 a[60:63], v[128:131], v[28:31], a[60:63]
    ds_read_b64_tr_b16 v[120:121], v105 offset:20512
    v_mfma_f32_16x16x32_bf16 a[64:67], v[128:131], v[32:35], a[64:67]
    ds_read_b64_tr_b16 v[122:123], v105 offset:25632
    s_add_u32 m0, s17, 23552
    v_mfma_f32_16x16x32_bf16 a[68:71], v[128:131], v[36:39], a[68:71]
    buffer_load_dwordx4 v147, s[20:23], s71 offen lds
    s_waitcnt lgkmcnt(10)
    v_mfma_f32_16x16x32_bf16 a[72:75], v[64:67], v[28:31], a[72:75]
    ds_read_b64_tr_b16 v[124:125], v104 offset:20544
    v_mfma_f32_16x16x32_bf16 a[76:79], v[64:67], v[32:35], a[76:79]
    ds_read_b64_tr_b16 v[126:127], v104 offset:25664
    v_mfma_f32_16x16x32_bf16 a[80:83], v[64:67], v[36:39], a[80:83]
    s_waitcnt lgkmcnt(10)
    v_mfma_f32_16x16x32_bf16 a[84:87], v[68:71], v[28:31], a[84:87]
    ds_read_b64_tr_b16 v[128:129], v105 offset:20576
    s_add_u32 m0, s17, 24576
    v_mfma_f32_16x16x32_bf16 a[88:91], v[68:71], v[32:35], a[88:91]
    ds_read_b64_tr_b16 v[130:131], v105 offset:25696
    buffer_load_dwordx4 v148, s[20:23], s71 offen lds
    v_mfma_f32_16x16x32_bf16 a[92:95], v[68:71], v[36:39], a[92:95]
    s_waitcnt lgkmcnt(10)
    v_mfma_f32_16x16x32_bf16 v[80:83], v[72:75], v[28:31], v[80:83]
    ds_read_b64_tr_b16 v[64:65], v104 offset:20608
    v_mfma_f32_16x16x32_bf16 v[84:87], v[72:75], v[32:35], v[84:87]
    ds_read_b64_tr_b16 v[66:67], v104 offset:25728
    v_mfma_f32_16x16x32_bf16 v[88:91], v[72:75], v[36:39], v[88:91]
    s_waitcnt lgkmcnt(10)
    v_mfma_f32_16x16x32_bf16 v[92:95], v[76:79], v[28:31], v[92:95]
    ds_read_b64_tr_b16 v[68:69], v105 offset:20640
    v_mfma_f32_16x16x32_bf16 v[96:99], v[76:79], v[32:35], v[96:99]
    ds_read_b64_tr_b16 v[70:71], v105 offset:25760
    v_mfma_f32_16x16x32_bf16 v[100:103], v[76:79], v[36:39], v[100:103]
    s_waitcnt vmcnt(5)
    s_barrier
    s_cmp_eq_u32 s3, 0
    s_cbranch_scc0 L_sig_skip
    s_lshl_b32 s40, s11, 7
    s_lshl_b32 s41, s10, 2
    s_add_u32 s40, s40, s41
    s_add_u32 s40, s40, 50331648
    s_mov_b64 exec, 1
    v_mov_b32 v11, s40
    v_mov_b32 v12, 1
    global_store_dword v11, v12, s[60:61]
    s_mov_b64 exec, -1
    s_lshl_b32 s40, s11, 2
    s_mov_b64 exec, 1
    v_mov_b32 v11, s40
    v_mov_b32 v12, 65536
    global_atomic_add v11, v12, s[62:63]
    s_mov_b64 exec, -1
L_sig_skip:
    s_waitcnt lgkmcnt(10)
    v_mfma_f32_16x16x32_bf16 a[0:3], v[116:119], v[40:43], a[0:3]
    ds_read_b64_tr_b16 v[72:73], v104 offset:20672
    v_mfma_f32_16x16x32_bf16 a[4:7], v[116:119], v[44:47], a[4:7]
    ds_read_b64_tr_b16 v[74:75], v104 offset:25792
    v_mfma_f32_16x16x32_bf16 a[8:11], v[116:119], v[48:51], a[8:11]
    s_waitcnt lgkmcnt(10)
    v_mfma_f32_16x16x32_bf16 a[12:15], v[120:123], v[40:43], a[12:15]
    ds_read_b64_tr_b16 v[76:77], v105 offset:20704
    s_add_u32 m0, s78, 0
    v_mfma_f32_16x16x32_bf16 a[16:19], v[120:123], v[44:47], a[16:19]
    ds_read_b64_tr_b16 v[78:79], v105 offset:25824
    buffer_load_dwordx4 v144, s[20:23], s46 offen lds
    v_mfma_f32_16x16x32_bf16 a[20:23], v[120:123], v[48:51], a[20:23]
    s_waitcnt lgkmcnt(10)
    v_mfma_f32_16x16x32_bf16 a[24:27], v[124:127], v[40:43], a[24:27]
    ds_read_b64_tr_b16 v[116:117], v104 offset:20736
    v_mfma_f32_16x16x32_bf16 a[28:31], v[124:127], v[44:47], a[28:31]
    ds_read_b64_tr_b16 v[118:119], v104 offset:25856
    v_mfma_f32_16x16x32_bf16 a[32:35], v[124:127], v[48:51], a[32:35]
    s_waitcnt lgkmcnt(10)
    v_mfma_f32_16x16x32_bf16 a[36:39], v[128:131], v[40:43], a[36:39]
    ds_read_b64_tr_b16 v[120:121], v105 offset:20768
    s_add_u32 m0, s78, 1024
    v_mfma_f32_16x16x32_bf16 a[40:43], v[128:131], v[44:47], a[40:43]
    ds_read_b64_tr_b16 v[122:123], v105 offset:25888
    buffer_load_dwordx4 v145, s[20:23], s46 offen lds
    v_mfma_f32_16x16x32_bf16 a[44:47], v[128:131], v[48:51], a[44:47]
    s_waitcnt lgkmcnt(10)
    v_mfma_f32_16x16x32_bf16 a[48:51], v[64:67], v[40:43], a[48:51]
    ds_read_b64_tr_b16 v[124:125], v104 offset:30720
    v_mfma_f32_16x16x32_bf16 a[52:55], v[64:67], v[44:47], a[52:55]
    ds_read_b64_tr_b16 v[126:127], v104 offset:35840
    v_mfma_f32_16x16x32_bf16 a[56:59], v[64:67], v[48:51], a[56:59]
    s_waitcnt lgkmcnt(10)
    v_mfma_f32_16x16x32_bf16 a[60:63], v[68:71], v[40:43], a[60:63]
    ds_read_b64_tr_b16 v[128:129], v105 offset:30752
    v_mfma_f32_16x16x32_bf16 a[64:67], v[68:71], v[44:47], a[64:67]
    ds_read_b64_tr_b16 v[130:131], v105 offset:35872
    v_mfma_f32_16x16x32_bf16 a[68:71], v[68:71], v[48:51], a[68:71]
    s_waitcnt lgkmcnt(10)
    v_mfma_f32_16x16x32_bf16 a[72:75], v[72:75], v[40:43], a[72:75]
    ds_read_b64_tr_b16 v[64:65], v104 offset:30784
    s_add_u32 m0, s78, 2048
    v_mfma_f32_16x16x32_bf16 a[76:79], v[72:75], v[44:47], a[76:79]
    ds_read_b64_tr_b16 v[66:67], v104 offset:35904
    buffer_load_dwordx4 v146, s[20:23], s46 offen lds
    v_mfma_f32_16x16x32_bf16 a[80:83], v[72:75], v[48:51], a[80:83]
    s_waitcnt lgkmcnt(10)
    v_mfma_f32_16x16x32_bf16 a[84:87], v[76:79], v[40:43], a[84:87]
    ds_read_b64_tr_b16 v[68:69], v105 offset:30816
    v_mfma_f32_16x16x32_bf16 a[88:91], v[76:79], v[44:47], a[88:91]
    ds_read_b64_tr_b16 v[70:71], v105 offset:35936
    v_mfma_f32_16x16x32_bf16 a[92:95], v[76:79], v[48:51], a[92:95]
    s_waitcnt lgkmcnt(10)
    v_mfma_f32_16x16x32_bf16 v[80:83], v[116:119], v[40:43], v[80:83]
    ds_read_b64_tr_b16 v[72:73], v104 offset:30848
    v_mfma_f32_16x16x32_bf16 v[84:87], v[116:119], v[44:47], v[84:87]
    ds_read_b64_tr_b16 v[74:75], v104 offset:35968
    v_mfma_f32_16x16x32_bf16 v[88:91], v[116:119], v[48:51], v[88:91]
    s_waitcnt lgkmcnt(10)
    v_mfma_f32_16x16x32_bf16 v[92:95], v[120:123], v[40:43], v[92:95]
    ds_read_b64_tr_b16 v[76:77], v105 offset:30880
    v_mfma_f32_16x16x32_bf16 v[96:99], v[120:123], v[44:47], v[96:99]
    ds_read_b64_tr_b16 v[78:79], v105 offset:36000
    v_mfma_f32_16x16x32_bf16 v[100:103], v[120:123], v[48:51], v[100:103]
    s_waitcnt lgkmcnt(10)
    v_mfma_f32_16x16x32_bf16 a[0:3], v[124:127], v[52:55], a[0:3]
    ds_read_b64_tr_b16 v[116:117], v104 offset:30912
    v_mfma_f32_16x16x32_bf16 a[4:7], v[124:127], v[56:59], a[4:7]
    ds_read_b64_tr_b16 v[118:119], v104 offset:36032
    v_mfma_f32_16x16x32_bf16 a[8:11], v[124:127], v[60:63], a[8:11]
    s_waitcnt lgkmcnt(10)
    v_mfma_f32_16x16x32_bf16 a[12:15], v[128:131], v[52:55], a[12:15]
    ds_read_b64_tr_b16 v[120:121], v105 offset:30944
    s_add_u32 m0, s78, 3072
    v_mfma_f32_16x16x32_bf16 a[16:19], v[128:131], v[56:59], a[16:19]
    ds_read_b64_tr_b16 v[122:123], v105 offset:36064
    buffer_load_dwordx4 v147, s[20:23], s46 offen lds
    v_mfma_f32_16x16x32_bf16 a[20:23], v[128:131], v[60:63], a[20:23]
    s_waitcnt lgkmcnt(10)
    v_mfma_f32_16x16x32_bf16 a[24:27], v[64:67], v[52:55], a[24:27]
    ds_read_b64_tr_b16 v[124:125], v104 offset:30976
    v_mfma_f32_16x16x32_bf16 a[28:31], v[64:67], v[56:59], a[28:31]
    ds_read_b64_tr_b16 v[126:127], v104 offset:36096
    v_mfma_f32_16x16x32_bf16 a[32:35], v[64:67], v[60:63], a[32:35]
    s_waitcnt lgkmcnt(10)
    v_mfma_f32_16x16x32_bf16 a[36:39], v[68:71], v[52:55], a[36:39]
    ds_read_b64_tr_b16 v[128:129], v105 offset:31008
    s_add_u32 m0, s78, 4096
    v_mfma_f32_16x16x32_bf16 a[40:43], v[68:71], v[56:59], a[40:43]
    ds_read_b64_tr_b16 v[130:131], v105 offset:36128
    buffer_load_dwordx4 v148, s[20:23], s46 offen lds
    v_mfma_f32_16x16x32_bf16 a[44:47], v[68:71], v[60:63], a[44:47]
    s_waitcnt lgkmcnt(10)
    v_mfma_f32_16x16x32_bf16 a[48:51], v[72:75], v[52:55], a[48:51]
    ds_read_b64_tr_b16 v[64:65], v111 offset:0
    v_mfma_f32_16x16x32_bf16 a[52:55], v[72:75], v[56:59], a[52:55]
    ds_read_b64_tr_b16 v[66:67], v111 offset:5120
    v_mfma_f32_16x16x32_bf16 a[56:59], v[72:75], v[60:63], a[56:59]
    s_waitcnt lgkmcnt(10)
    v_mfma_f32_16x16x32_bf16 a[60:63], v[76:79], v[52:55], a[60:63]
    ds_read_b64_tr_b16 v[68:69], v112 offset:32
    v_mfma_f32_16x16x32_bf16 a[64:67], v[76:79], v[56:59], a[64:67]
    ds_read_b64_tr_b16 v[70:71], v112 offset:5152
    v_mfma_f32_16x16x32_bf16 a[68:71], v[76:79], v[60:63], a[68:71]
    s_waitcnt lgkmcnt(10)
    v_mfma_f32_16x16x32_bf16 a[72:75], v[116:119], v[52:55], a[72:75]
    ds_read_b64_tr_b16 v[72:73], v111 offset:64
    v_mfma_f32_16x16x32_bf16 a[76:79], v[116:119], v[56:59], a[76:79]
    ds_read_b64_tr_b16 v[74:75], v111 offset:5184
    v_mfma_f32_16x16x32_bf16 a[80:83], v[116:119], v[60:63], a[80:83]
    s_waitcnt lgkmcnt(10)
    v_mfma_f32_16x16x32_bf16 a[84:87], v[120:123], v[52:55], a[84:87]
    ds_read_b64_tr_b16 v[76:77], v112 offset:96
    v_mfma_f32_16x16x32_bf16 a[88:91], v[120:123], v[56:59], a[88:91]
    ds_read_b64_tr_b16 v[78:79], v112 offset:5216
    v_mfma_f32_16x16x32_bf16 a[92:95], v[120:123], v[60:63], a[92:95]
    s_waitcnt lgkmcnt(10)
    v_mfma_f32_16x16x32_bf16 v[80:83], v[124:127], v[52:55], v[80:83]
    ds_read_b64_tr_b16 v[116:117], v111 offset:128
    v_mfma_f32_16x16x32_bf16 v[84:87], v[124:127], v[56:59], v[84:87]
    ds_read_b64_tr_b16 v[118:119], v111 offset:5248
    v_mfma_f32_16x16x32_bf16 v[88:91], v[124:127], v[60:63], v[88:91]
    s_waitcnt lgkmcnt(10)
    v_mfma_f32_16x16x32_bf16 v[92:95], v[128:131], v[52:55], v[92:95]
    ds_read_b64_tr_b16 v[120:121], v112 offset:160
    v_mfma_f32_16x16x32_bf16 v[96:99], v[128:131], v[56:59], v[96:99]
    ds_read_b64_tr_b16 v[122:123], v112 offset:5280
    v_mfma_f32_16x16x32_bf16 v[100:103], v[128:131], v[60:63], v[100:103]
    v_swap_b32 v104, v111
    v_swap_b32 v105, v112
    s_mov_b32 s40, s78
    s_mov_b32 s78, s17
    s_mov_b32 s17, s40
    s_mov_b32 s44, s45
    s_mov_b32 s45, s46
    s_mov_b32 s46, s47
    s_mov_b32 s47, 2130706432
    s_mov_b32 s48, s49
    s_mov_b32 s49, s50
    s_mov_b32 s50, s51
    s_mov_b32 s51, 2130706432
    s_cmp_eq_u32 s3, 0
    s_cbranch_scc0 L_poll_skip
    s_cmp_eq_u32 s9, 1
    s_cbranch_scc0 L_poll_slow
    s_lshl_b32 s40, s11, 7
    s_add_u32 s40, s40, 50331648
    v_mov_b32 v11, s40
L_pollfast:
    global_load_dwordx4 v[140:143], v11, s[60:61] sc1
    s_waitcnt vmcnt(0)
    v_and_b32 v140, v140, v141
    v_and_b32 v142, v142, v143
    v_and_b32 v140, v140, v142
    s_nop 0
    v_readfirstlane_b32 s41, v140
    s_nop 2
    s_cmp_eq_u32 s41, 1
    s_cbranch_scc1 L_poll_skip
    s_branch L_pollfast
L_poll_slow:
    s_lshl_b32 s40, s11, 2
    v_mov_b32 v11, s40
L_polla:
    global_load_dword v12, v11, s[62:63] sc1
    s_waitcnt vmcnt(0)
    v_readfirstlane_b32 s41, v12
    s_nop 2
    s_bfe_u32 s41, s41, 196624
    s_cmp_eq_u32 s41, 4
    s_cbranch_scc1 L_polla_done
    s_sleep 1
    s_branch L_polla
L_polla_done:
L_poll_skip:
    s_barrier
    s_mov_b32 s40, 2130706432
    s_waitcnt vmcnt(0)
    buffer_load_dwordx4 v[16:19], v0, s[24:27], s48 offen offset:0 sc1
    buffer_load_dwordx4 v[20:23], v133, s[24:27], s48 offen offset:0 sc1
    buffer_load_dwordx4 v[24:27], v134, s[24:27], s48 offen offset:0 sc1
    buffer_load_dwordx4 v[28:31], v0, s[24:27], s48 offen offset:1024 sc1
    buffer_load_dword v135, v0, s[24:27], s40 offen
    buffer_load_dwordx4 v[32:35], v133, s[24:27], s48 offen offset:1024 sc1
    buffer_load_dword v135, v0, s[24:27], s40 offen
    buffer_load_dwordx4 v[36:39], v134, s[24:27], s48 offen offset:1024 sc1
    buffer_load_dword v135, v0, s[24:27], s40 offen
    buffer_load_dwordx4 v[40:43], v0, s[24:27], s48 offen offset:2048 sc1
    buffer_load_dword v135, v0, s[24:27], s40 offen
    buffer_load_dwordx4 v[44:47], v133, s[24:27], s48 offen offset:2048 sc1
    buffer_load_dword v135, v0, s[24:27], s40 offen
    buffer_load_dwordx4 v[48:51], v134, s[24:27], s48 offen offset:2048 sc1
    s_mov_b32 s72, 0
.p2align 6
L_op_loop:
    s_waitcnt vmcnt(11)
    s_barrier
    s_waitcnt lgkmcnt(10)
    v_mfma_f32_16x16x32_bf16 a[0:3], v[64:67], v[16:19], a[0:3]
    ds_read_b64_tr_b16 v[124:125], v104 offset:192
    s_add_u32 s41, s45, 81920
    v_mfma_f32_16x16x32_bf16 a[4:7], v[64:67], v[20:23], a[4:7]
    ds_read_b64_tr_b16 v[126:127], v104 offset:5312
    buffer_load_dwordx4 v[52:55], v0, s[24:27], s48 offen offset:3072 sc1
    v_mfma_f32_16x16x32_bf16 a[8:11], v[64:67], v[24:27], a[8:11]
    s_waitcnt lgkmcnt(10)
    v_mfma_f32_16x16x32_bf16 a[12:15], v[68:71], v[16:19], a[12:15]
    ds_read_b64_tr_b16 v[128:129], v105 offset:224
    s_add_u32 m0, s17, 20480
    v_mfma_f32_16x16x32_bf16 a[16:19], v[68:71], v[20:23], a[16:19]
    ds_read_b64_tr_b16 v[130:131], v105 offset:5344
    buffer_load_dwordx4 v144, s[20:23], s41 offen lds
    v_mfma_f32_16x16x32_bf16 a[20:23], v[68:71], v[24:27], a[20:23]
    s_waitcnt lgkmcnt(10)
    v_mfma_f32_16x16x32_bf16 a[24:27], v[72:75], v[16:19], a[24:27]
    ds_read_b64_tr_b16 v[64:65], v104 offset:256
    v_mfma_f32_16x16x32_bf16 a[28:31], v[72:75], v[20:23], a[28:31]
    ds_read_b64_tr_b16 v[66:67], v104 offset:5376
    buffer_load_dwordx4 v[56:59], v133, s[24:27], s48 offen offset:3072 sc1
    v_mfma_f32_16x16x32_bf16 a[32:35], v[72:75], v[24:27], a[32:35]
    s_waitcnt lgkmcnt(10)
    v_mfma_f32_16x16x32_bf16 a[36:39], v[76:79], v[16:19], a[36:39]
    ds_read_b64_tr_b16 v[68:69], v105 offset:288
    s_add_u32 m0, s17, 21504
    v_mfma_f32_16x16x32_bf16 a[40:43], v[76:79], v[20:23], a[40:43]
    ds_read_b64_tr_b16 v[70:71], v105 offset:5408
    buffer_load_dwordx4 v145, s[20:23], s41 offen lds
    v_mfma_f32_16x16x32_bf16 a[44:47], v[76:79], v[24:27], a[44:47]
    s_waitcnt lgkmcnt(10)
    v_mfma_f32_16x16x32_bf16 a[48:51], v[116:119], v[16:19], a[48:51]
    ds_read_b64_tr_b16 v[72:73], v104 offset:10240
    v_mfma_f32_16x16x32_bf16 a[52:55], v[116:119], v[20:23], a[52:55]
    ds_read_b64_tr_b16 v[74:75], v104 offset:15360
    buffer_load_dwordx4 v[60:63], v134, s[24:27], s48 offen offset:3072 sc1
    v_mfma_f32_16x16x32_bf16 a[56:59], v[116:119], v[24:27], a[56:59]
    s_waitcnt lgkmcnt(10)
    v_mfma_f32_16x16x32_bf16 a[60:63], v[120:123], v[16:19], a[60:63]
    ds_read_b64_tr_b16 v[76:77], v105 offset:10272
    v_mfma_f32_16x16x32_bf16 a[64:67], v[120:123], v[20:23], a[64:67]
    ds_read_b64_tr_b16 v[78:79], v105 offset:15392
    v_mfma_f32_16x16x32_bf16 a[68:71], v[120:123], v[24:27], a[68:71]
    s_waitcnt lgkmcnt(10)
    v_mfma_f32_16x16x32_bf16 a[72:75], v[124:127], v[16:19], a[72:75]
    ds_read_b64_tr_b16 v[116:117], v104 offset:10304
    s_add_u32 m0, s17, 22528
    v_mfma_f32_16x16x32_bf16 a[76:79], v[124:127], v[20:23], a[76:79]
    ds_read_b64_tr_b16 v[118:119], v104 offset:15424
    buffer_load_dwordx4 v146, s[20:23], s41 offen lds
    v_mfma_f32_16x16x32_bf16 a[80:83], v[124:127], v[24:27], a[80:83]
    s_waitcnt lgkmcnt(10)
    v_mfma_f32_16x16x32_bf16 a[84:87], v[128:131], v[16:19], a[84:87]
    ds_read_b64_tr_b16 v[120:121], v105 offset:10336
    v_mfma_f32_16x16x32_bf16 a[88:91], v[128:131], v[20:23], a[88:91]
    ds_read_b64_tr_b16 v[122:123], v105 offset:15456
    v_mfma_f32_16x16x32_bf16 a[92:95], v[128:131], v[24:27], a[92:95]
    s_waitcnt lgkmcnt(10)
    v_mfma_f32_16x16x32_bf16 v[80:83], v[64:67], v[16:19], v[80:83]
    ds_read_b64_tr_b16 v[124:125], v104 offset:10368
    v_mfma_f32_16x16x32_bf16 v[84:87], v[64:67], v[20:23], v[84:87]
    ds_read_b64_tr_b16 v[126:127], v104 offset:15488
    v_mfma_f32_16x16x32_bf16 v[88:91], v[64:67], v[24:27], v[88:91]
    s_waitcnt lgkmcnt(10)
    v_mfma_f32_16x16x32_bf16 v[92:95], v[68:71], v[16:19], v[92:95]
    ds_read_b64_tr_b16 v[128:129], v105 offset:10400
    v_mfma_f32_16x16x32_bf16 v[96:99], v[68:71], v[20:23], v[96:99]
    ds_read_b64_tr_b16 v[130:131], v105 offset:15520
    v_mfma_f32_16x16x32_bf16 v[100:103], v[68:71], v[24:27], v[100:103]
    s_waitcnt vmcnt(12)
    s_waitcnt lgkmcnt(10)
    v_mfma_f32_16x16x32_bf16 a[0:3], v[72:75], v[28:31], a[0:3]
    ds_read_b64_tr_b16 v[64:65], v104 offset:10432
    v_mfma_f32_16x16x32_bf16 a[4:7], v[72:75], v[32:35], a[4:7]
    ds_read_b64_tr_b16 v[66:67], v104 offset:15552
    buffer_load_dwordx4 v[16:19], v0, s[24:27], s49 offen offset:0 sc1
    v_mfma_f32_16x16x32_bf16 a[8:11], v[72:75], v[36:39], a[8:11]
    s_waitcnt lgkmcnt(10)
    v_mfma_f32_16x16x32_bf16 a[12:15], v[76:79], v[28:31], a[12:15]
    ds_read_b64_tr_b16 v[68:69], v105 offset:10464
    s_add_u32 m0, s17, 23552
    v_mfma_f32_16x16x32_bf16 a[16:19], v[76:79], v[32:35], a[16:19]
    ds_read_b64_tr_b16 v[70:71], v105 offset:15584
    buffer_load_dwordx4 v147, s[20:23], s41 offen lds
    v_mfma_f32_16x16x32_bf16 a[20:23], v[76:79], v[36:39], a[20:23]
    s_waitcnt lgkmcnt(10)
    v_mfma_f32_16x16x32_bf16 a[24:27], v[116:119], v[28:31], a[24:27]
    ds_read_b64_tr_b16 v[72:73], v104 offset:10496
    v_mfma_f32_16x16x32_bf16 a[28:31], v[116:119], v[32:35], a[28:31]
    ds_read_b64_tr_b16 v[74:75], v104 offset:15616
    buffer_load_dwordx4 v[20:23], v133, s[24:27], s49 offen offset:0 sc1
    v_mfma_f32_16x16x32_bf16 a[32:35], v[116:119], v[36:39], a[32:35]
    s_waitcnt lgkmcnt(10)
    v_mfma_f32_16x16x32_bf16 a[36:39], v[120:123], v[28:31], a[36:39]
    ds_read_b64_tr_b16 v[76:77], v105 offset:10528
    s_add_u32 m0, s17, 24576
    v_mfma_f32_16x16x32_bf16 a[40:43], v[120:123], v[32:35], a[40:43]
    ds_read_b64_tr_b16 v[78:79], v105 offset:15648
    buffer_load_dwordx4 v148, s[20:23], s41 offen lds
    v_mfma_f32_16x16x32_bf16 a[44:47], v[120:123], v[36:39], a[44:47]
    s_waitcnt lgkmcnt(10)
    v_mfma_f32_16x16x32_bf16 a[48:51], v[124:127], v[28:31], a[48:51]
    ds_read_b64_tr_b16 v[116:117], v104 offset:20480
    v_mfma_f32_16x16x32_bf16 a[52:55], v[124:127], v[32:35], a[52:55]
    ds_read_b64_tr_b16 v[118:119], v104 offset:25600
    buffer_load_dwordx4 v[24:27], v134, s[24:27], s49 offen offset:0 sc1
    v_mfma_f32_16x16x32_bf16 a[56:59], v[124:127], v[36:39], a[56:59]
    s_waitcnt lgkmcnt(10)
    v_mfma_f32_16x16x32_bf16 a[60:63], v[128:131], v[28:31], a[60:63]
    ds_read_b64_tr_b16 v[120:121], v105 offset:20512
    v_mfma_f32_16x16x32_bf16 a[64:67], v[128:131], v[32:35], a[64:67]
    ds_read_b64_tr_b16 v[122:123], v105 offset:25632
    v_mfma_f32_16x16x32_bf16 a[68:71], v[128:131], v[36:39], a[68:71]
    s_waitcnt lgkmcnt(10)
    v_mfma_f32_16x16x32_bf16 a[72:75], v[64:67], v[28:31], a[72:75]
    ds_read_b64_tr_b16 v[124:125], v104 offset:20544
    v_mfma_f32_16x16x32_bf16 a[76:79], v[64:67], v[32:35], a[76:79]
    ds_read_b64_tr_b16 v[126:127], v104 offset:25664
    v_mfma_f32_16x16x32_bf16 a[80:83], v[64:67], v[36:39], a[80:83]
    s_waitcnt lgkmcnt(10)
    v_mfma_f32_16x16x32_bf16 a[84:87], v[68:71], v[28:31], a[84:87]
    ds_read_b64_tr_b16 v[128:129], v105 offset:20576
    v_mfma_f32_16x16x32_bf16 a[88:91], v[68:71], v[32:35], a[88:91]
    ds_read_b64_tr_b16 v[130:131], v105 offset:25696
    v_mfma_f32_16x16x32_bf16 a[92:95], v[68:71], v[36:39], a[92:95]
    s_waitcnt lgkmcnt(10)
    v_mfma_f32_16x16x32_bf16 v[80:83], v[72:75], v[28:31], v[80:83]
    ds_read_b64_tr_b16 v[64:65], v104 offset:20608
    v_mfma_f32_16x16x32_bf16 v[84:87], v[72:75], v[32:35], v[84:87]
    ds_read_b64_tr_b16 v[66:67], v104 offset:25728
    v_mfma_f32_16x16x32_bf16 v[88:91], v[72:75], v[36:39], v[88:91]
    s_waitcnt lgkmcnt(10)
    v_mfma_f32_16x16x32_bf16 v[92:95], v[76:79], v[28:31], v[92:95]
    ds_read_b64_tr_b16 v[68:69], v105 offset:20640
    v_mfma_f32_16x16x32_bf16 v[96:99], v[76:79], v[32:35], v[96:99]
    ds_read_b64_tr_b16 v[70:71], v105 offset:25760
    v_mfma_f32_16x16x32_bf16 v[100:103], v[76:79], v[36:39], v[100:103]
    s_waitcnt vmcnt(11)
    s_barrier
    s_waitcnt lgkmcnt(10)
    v_mfma_f32_16x16x32_bf16 a[0:3], v[116:119], v[40:43], a[0:3]
    ds_read_b64_tr_b16 v[72:73], v104 offset:20672
    v_mfma_f32_16x16x32_bf16 a[4:7], v[116:119], v[44:47], a[4:7]
    ds_read_b64_tr_b16 v[74:75], v104 offset:25792
    buffer_load_dwordx4 v[28:31], v0, s[24:27], s49 offen offset:1024 sc1
    v_mfma_f32_16x16x32_bf16 a[8:11], v[116:119], v[48:51], a[8:11]
    s_waitcnt lgkmcnt(10)
    v_mfma_f32_16x16x32_bf16 a[12:15], v[120:123], v[40:43], a[12:15]
    ds_read_b64_tr_b16 v[76:77], v105 offset:20704
    s_add_u32 m0, s78, 0
    v_mfma_f32_16x16x32_bf16 a[16:19], v[120:123], v[44:47], a[16:19]
    ds_read_b64_tr_b16 v[78:79], v105 offset:25824
    buffer_load_dwordx4 v144, s[20:23], s46 offen lds
    v_mfma_f32_16x16x32_bf16 a[20:23], v[120:123], v[48:51], a[20:23]
    s_waitcnt lgkmcnt(10)
    v_mfma_f32_16x16x32_bf16 a[24:27], v[124:127], v[40:43], a[24:27]
    ds_read_b64_tr_b16 v[116:117], v104 offset:20736
    v_mfma_f32_16x16x32_bf16 a[28:31], v[124:127], v[44:47], a[28:31]
    ds_read_b64_tr_b16 v[118:119], v104 offset:25856
    buffer_load_dwordx4 v[32:35], v133, s[24:27], s49 offen offset:1024 sc1
    v_mfma_f32_16x16x32_bf16 a[32:35], v[124:127], v[48:51], a[32:35]
    s_waitcnt lgkmcnt(10)
    v_mfma_f32_16x16x32_bf16 a[36:39], v[128:131], v[40:43], a[36:39]
    ds_read_b64_tr_b16 v[120:121], v105 offset:20768
    s_add_u32 m0, s78, 1024
    v_mfma_f32_16x16x32_bf16 a[40:43], v[128:131], v[44:47], a[40:43]
    ds_read_b64_tr_b16 v[122:123], v105 offset:25888
    buffer_load_dwordx4 v145, s[20:23], s46 offen lds
    v_mfma_f32_16x16x32_bf16 a[44:47], v[128:131], v[48:51], a[44:47]
    s_waitcnt lgkmcnt(10)
    v_mfma_f32_16x16x32_bf16 a[48:51], v[64:67], v[40:43], a[48:51]
    ds_read_b64_tr_b16 v[124:125], v104 offset:30720
    v_mfma_f32_16x16x32_bf16 a[52:55], v[64:67], v[44:47], a[52:55]
    ds_read_b64_tr_b16 v[126:127], v104 offset:35840
    buffer_load_dwordx4 v[36:39], v134, s[24:27], s49 offen offset:1024 sc1
    v_mfma_f32_16x16x32_bf16 a[56:59], v[64:67], v[48:51], a[56:59]
    s_waitcnt lgkmcnt(10)
    v_mfma_f32_16x16x32_bf16 a[60:63], v[68:71], v[40:43], a[60:63]
    ds_read_b64_tr_b16 v[128:129], v105 offset:30752
    v_mfma_f32_16x16x32_bf16 a[64:67], v[68:71], v[44:47], a[64:67]
    ds_read_b64_tr_b16 v[130:131], v105 offset:35872
    v_mfma_f32_16x16x32_bf16 a[68:71], v[68:71], v[48:51], a[68:71]
    s_waitcnt lgkmcnt(10)
    v_mfma_f32_16x16x32_bf16 a[72:75], v[72:75], v[40:43], a[72:75]
    ds_read_b64_tr_b16 v[64:65], v104 offset:30784
    s_add_u32 m0, s78, 2048
    v_mfma_f32_16x16x32_bf16 a[76:79], v[72:75], v[44:47], a[76:79]
    ds_read_b64_tr_b16 v[66:67], v104 offset:35904
    buffer_load_dwordx4 v146, s[20:23], s46 offen lds
    v_mfma_f32_16x16x32_bf16 a[80:83], v[72:75], v[48:51], a[80:83]
    s_waitcnt lgkmcnt(10)
    v_mfma_f32_16x16x32_bf16 a[84:87], v[76:79], v[40:43], a[84:87]
    ds_read_b64_tr_b16 v[68:69], v105 offset:30816
    v_mfma_f32_16x16x32_bf16 a[88:91], v[76:79], v[44:47], a[88:91]
    ds_read_b64_tr_b16 v[70:71], v105 offset:35936
    v_mfma_f32_16x16x32_bf16 a[92:95], v[76:79], v[48:51], a[92:95]
    s_waitcnt lgkmcnt(10)
    v_mfma_f32_16x16x32_bf16 v[80:83], v[116:119], v[40:43], v[80:83]
    ds_read_b64_tr_b16 v[72:73], v104 offset:30848
    v_mfma_f32_16x16x32_bf16 v[84:87], v[116:119], v[44:47], v[84:87]
    ds_read_b64_tr_b16 v[74:75], v104 offset:35968
    v_mfma_f32_16x16x32_bf16 v[88:91], v[116:119], v[48:51], v[88:91]
    s_waitcnt lgkmcnt(10)
    v_mfma_f32_16x16x32_bf16 v[92:95], v[120:123], v[40:43], v[92:95]
    ds_read_b64_tr_b16 v[76:77], v105 offset:30880
    v_mfma_f32_16x16x32_bf16 v[96:99], v[120:123], v[44:47], v[96:99]
    ds_read_b64_tr_b16 v[78:79], v105 offset:36000
    v_mfma_f32_16x16x32_bf16 v[100:103], v[120:123], v[48:51], v[100:103]
    s_waitcnt vmcnt(12)
    s_waitcnt lgkmcnt(10)
    v_mfma_f32_16x16x32_bf16 a[0:3], v[124:127], v[52:55], a[0:3]
    ds_read_b64_tr_b16 v[116:117], v104 offset:30912
    v_mfma_f32_16x16x32_bf16 a[4:7], v[124:127], v[56:59], a[4:7]
    ds_read_b64_tr_b16 v[118:119], v104 offset:36032
    buffer_load_dwordx4 v[40:43], v0, s[24:27], s49 offen offset:2048 sc1
    v_mfma_f32_16x16x32_bf16 a[8:11], v[124:127], v[60:63], a[8:11]
    s_waitcnt lgkmcnt(10)
    v_mfma_f32_16x16x32_bf16 a[12:15], v[128:131], v[52:55], a[12:15]
    ds_read_b64_tr_b16 v[120:121], v105 offset:30944
    s_add_u32 m0, s78, 3072
    v_mfma_f32_16x16x32_bf16 a[16:19], v[128:131], v[56:59], a[16:19]
    ds_read_b64_tr_b16 v[122:123], v105 offset:36064
    buffer_load_dwordx4 v147, s[20:23], s46 offen lds
    v_mfma_f32_16x16x32_bf16 a[20:23], v[128:131], v[60:63], a[20:23]
    s_waitcnt lgkmcnt(10)
    v_mfma_f32_16x16x32_bf16 a[24:27], v[64:67], v[52:55], a[24:27]
    ds_read_b64_tr_b16 v[124:125], v104 offset:30976
    v_mfma_f32_16x16x32_bf16 a[28:31], v[64:67], v[56:59], a[28:31]
    ds_read_b64_tr_b16 v[126:127], v104 offset:36096
    buffer_load_dwordx4 v[44:47], v133, s[24:27], s49 offen offset:2048 sc1
    v_mfma_f32_16x16x32_bf16 a[32:35], v[64:67], v[60:63], a[32:35]
    s_waitcnt lgkmcnt(10)
    v_mfma_f32_16x16x32_bf16 a[36:39], v[68:71], v[52:55], a[36:39]
    ds_read_b64_tr_b16 v[128:129], v105 offset:31008
    s_add_u32 m0, s78, 4096
    v_mfma_f32_16x16x32_bf16 a[40:43], v[68:71], v[56:59], a[40:43]
    ds_read_b64_tr_b16 v[130:131], v105 offset:36128
    buffer_load_dwordx4 v148, s[20:23], s46 offen lds
    v_mfma_f32_16x16x32_bf16 a[44:47], v[68:71], v[60:63], a[44:47]
    s_waitcnt lgkmcnt(10)
    v_mfma_f32_16x16x32_bf16 a[48:51], v[72:75], v[52:55], a[48:51]
    ds_read_b64_tr_b16 v[64:65], v111 offset:0
    v_mfma_f32_16x16x32_bf16 a[52:55], v[72:75], v[56:59], a[52:55]
    ds_read_b64_tr_b16 v[66:67], v111 offset:5120
    buffer_load_dwordx4 v[48:51], v134, s[24:27], s49 offen offset:2048 sc1
    v_mfma_f32_16x16x32_bf16 a[56:59], v[72:75], v[60:63], a[56:59]
    s_waitcnt lgkmcnt(10)
    v_mfma_f32_16x16x32_bf16 a[60:63], v[76:79], v[52:55], a[60:63]
    ds_read_b64_tr_b16 v[68:69], v112 offset:32
    v_mfma_f32_16x16x32_bf16 a[64:67], v[76:79], v[56:59], a[64:67]
    ds_read_b64_tr_b16 v[70:71], v112 offset:5152
    v_mfma_f32_16x16x32_bf16 a[68:71], v[76:79], v[60:63], a[68:71]
    s_waitcnt lgkmcnt(10)
    v_mfma_f32_16x16x32_bf16 a[72:75], v[116:119], v[52:55], a[72:75]
    ds_read_b64_tr_b16 v[72:73], v111 offset:64
    v_mfma_f32_16x16x32_bf16 a[76:79], v[116:119], v[56:59], a[76:79]
    ds_read_b64_tr_b16 v[74:75], v111 offset:5184
    v_mfma_f32_16x16x32_bf16 a[80:83], v[116:119], v[60:63], a[80:83]
    s_waitcnt lgkmcnt(10)
    v_mfma_f32_16x16x32_bf16 a[84:87], v[120:123], v[52:55], a[84:87]
    ds_read_b64_tr_b16 v[76:77], v112 offset:96
    v_mfma_f32_16x16x32_bf16 a[88:91], v[120:123], v[56:59], a[88:91]
    ds_read_b64_tr_b16 v[78:79], v112 offset:5216
    v_mfma_f32_16x16x32_bf16 a[92:95], v[120:123], v[60:63], a[92:95]
    s_waitcnt lgkmcnt(10)
    v_mfma_f32_16x16x32_bf16 v[80:83], v[124:127], v[52:55], v[80:83]
    ds_read_b64_tr_b16 v[116:117], v111 offset:128
    v_mfma_f32_16x16x32_bf16 v[84:87], v[124:127], v[56:59], v[84:87]
    ds_read_b64_tr_b16 v[118:119], v111 offset:5248
    v_mfma_f32_16x16x32_bf16 v[88:91], v[124:127], v[60:63], v[88:91]
    s_waitcnt lgkmcnt(10)
    v_mfma_f32_16x16x32_bf16 v[92:95], v[128:131], v[52:55], v[92:95]
    ds_read_b64_tr_b16 v[120:121], v112 offset:160
    v_mfma_f32_16x16x32_bf16 v[96:99], v[128:131], v[56:59], v[96:99]
    ds_read_b64_tr_b16 v[122:123], v112 offset:5280
    v_mfma_f32_16x16x32_bf16 v[100:103], v[128:131], v[60:63], v[100:103]
    v_swap_b32 v104, v111
    v_swap_b32 v105, v112
    s_mov_b32 s40, s78
    s_mov_b32 s78, s17
    s_mov_b32 s17, s40
    s_mov_b32 s44, s45
    s_mov_b32 s45, s46
    s_mov_b32 s46, s47
    s_mov_b32 s47, 2130706432
    s_mov_b32 s48, s49
    s_mov_b32 s49, s50
    s_mov_b32 s50, s51
    s_mov_b32 s51, 2130706432
    s_add_u32 s72, s72, 1
    s_cmp_lt_u32 s72, 3
    s_cbranch_scc1 L_op_loop
L_op_after:
    s_waitcnt vmcnt(0) lgkmcnt(0)
    s_barrier
    s_lshl_b32 s40, s3, 14
    v_add_u32 v11, s40, v0
    s_xor_b32 s41, s3, 4
    s_lshl_b32 s41, s41, 14
    v_add_u32 v12, s41, v0
    s_lshl_b32 s40, s79, 2
    s_add_u32 s40, s40, s8
    s_mul_i32 s40, s40, 61440
    s_add_u32 s40, s40, 33554432
    s_mul_i32 s41, s74, 15360
    s_add_u32 s41, s41, s40
    s_add_u32 s28, s60, s41
    s_addc_u32 s29, s61, 0
    s_mov_b32 s30, 15360
    s_mov_b32 s31, 0x20000
    s_add_u32 s70, s8, s74
    s_and_b32 s70, s70, 3
    s_cmp_eq_u32 s4, 0
    s_cbranch_scc0 L_red_h1
    ds_write_b128 v11, a[76:79] offset:0
    ds_write_b128 v11, a[88:91] offset:1024
    ds_write_b128 v11, v[84:87] offset:2048
    ds_write_b128 v11, v[96:99] offset:3072
    ds_write_b128 v11, a[8:11] offset:4096
    ds_write_b128 v11, a[20:23] offset:5120
    ds_write_b128 v11, a[32:35] offset:6144
    ds_write_b128 v11, a[44:47] offset:7168
    ds_write_b128 v11, a[56:59] offset:8192
    ds_write_b128 v11, a[68:71] offset:9216
    ds_write_b128 v11, a[80:83] offset:10240
    ds_write_b128 v11, a[92:95] offset:11264
    ds_write_b128 v11, v[88:91] offset:12288
    ds_write_b128 v11, v[100:103] offset:13312
    s_waitcnt lgkmcnt(0)
    s_barrier
    ds_read_b128 v[16:19], v12 offset:0
    ds_read_b128 v[20:23], v12 offset:1024
    ds_read_b128 v[24:27], v12 offset:2048
    ds_read_b128 v[28:31], v12 offset:3072
    ds_read_b128 v[32:35], v12 offset:4096
    ds_read_b128 v[36:39], v12 offset:5120
    ds_read_b128 v[40:43], v12 offset:6144
    ds_read_b128 v[44:47], v12 offset:7168
    ds_read_b128 v[48:51], v12 offset:8192
    ds_read_b128 v[52:55], v12 offset:9216
    ds_read_b128 v[56:59], v12 offset:10240
    ds_read_b128 v[60:63], v12 offset:11264
    ds_read_b128 v[64:67], v12 offset:12288
    ds_read_b128 v[68:71], v12 offset:13312
    ds_read_b128 v[72:75], v12 offset:14336
    ds_read_b128 v[76:79], v12 offset:15360
    s_waitcnt lgkmcnt(14)
    v_accvgpr_read_b32 v132, a0
    v_add_f32 v16, v16, v132
    v_accvgpr_read_b32 v132, a1
    v_add_f32 v17, v17, v132
    v_accvgpr_read_b32 v132, a2
    v_add_f32 v18, v18, v132
    v_accvgpr_read_b32 v132, a3
    v_add_f32 v19, v19, v132
    v_accvgpr_read_b32 v132, a12
    v_add_f32 v20, v20, v132
    v_accvgpr_read_b32 v132, a13
    v_add_f32 v21, v21, v132
    v_accvgpr_read_b32 v132, a14
    v_add_f32 v22, v22, v132
    v_accvgpr_read_b32 v132, a15
    v_add_f32 v23, v23, v132
    s_cmp_eq_u32 s70, 0
    s_cbranch_scc1 L_own0
    v_cvt_pk_bf16_f32 v152, v16, v17
    v_cvt_pk_bf16_f32 v153, v18, v19
    v_cvt_pk_bf16_f32 v154, v20, v21
    v_cvt_pk_bf16_f32 v155, v22, v23
    s_mov_b32 s40, 0
    buffer_store_dwordx4 v[152:155], v0, s[28:31], s40 offen sc1
    s_branch L_next0
L_own0:
    v_mov_b32 v136, v16
    v_mov_b32 v137, v17
    v_mov_b32 v138, v18
    v_mov_b32 v139, v19
    v_mov_b32 v140, v20
    v_mov_b32 v141, v21
    v_mov_b32 v142, v22
    v_mov_b32 v143, v23
L_next0:
    s_waitcnt lgkmcnt(12)
    v_accvgpr_read_b32 v132, a24
    v_add_f32 v24, v24, v132
    v_accvgpr_read_b32 v132, a25
    v_add_f32 v25, v25, v132
    v_accvgpr_read_b32 v132, a26
    v_add_f32 v26, v26, v132
    v_accvgpr_read_b32 v132, a27
    v_add_f32 v27, v27, v132
    v_accvgpr_read_b32 v132, a36
    v_add_f32 v28, v28, v132
    v_accvgpr_read_b32 v132, a37
    v_add_f32 v29, v29, v132
    v_accvgpr_read_b32 v132, a38
    v_add_f32 v30, v30, v132
    v_accvgpr_read_b32 v132, a39
    v_add_f32 v31, v31, v132
    s_cmp_eq_u32 s70, 1
    s_cbranch_scc1 L_own1
    v_cvt_pk_bf16_f32 v156, v24, v25
    v_cvt_pk_bf16_f32 v157, v26, v27
    v_cvt_pk_bf16_f32 v158, v28, v29
    v_cvt_pk_bf16_f32 v159, v30, v31
    s_mov_b32 s40, 1024
    buffer_store_dwordx4 v[156:159], v0, s[28:31], s40 offen sc1
    s_branch L_next1
L_own1:
    v_mov_b32 v136, v24
    v_mov_b32 v137, v25
    v_mov_b32 v138, v26
    v_mov_b32 v139, v27
    v_mov_b32 v140, v28
    v_mov_b32 v141, v29
    v_mov_b32 v142, v30
    v_mov_b32 v143, v31
L_next1:
    s_waitcnt lgkmcnt(10)
    v_accvgpr_read_b32 v132, a48
    v_add_f32 v32, v32, v132
    v_accvgpr_read_b32 v132, a49
    v_add_f32 v33, v33, v132
    v_accvgpr_read_b32 v132, a50
    v_add_f32 v34, v34, v132
    v_accvgpr_read_b32 v132, a51
    v_add_f32 v35, v35, v132
    v_accvgpr_read_b32 v132, a60
    v_add_f32 v36, v36, v132
    v_accvgpr_read_b32 v132, a61
    v_add_f32 v37, v37, v132
    v_accvgpr_read_b32 v132, a62
    v_add_f32 v38, v38, v132
    v_accvgpr_read_b32 v132, a63
    v_add_f32 v39, v39, v132
    s_cmp_eq_u32 s70, 2
    s_cbranch_scc1 L_own2
    v_cvt_pk_bf16_f32 v152, v32, v33
    v_cvt_pk_bf16_f32 v153, v34, v35
    v_cvt_pk_bf16_f32 v154, v36, v37
    v_cvt_pk_bf16_f32 v155, v38, v39
    s_mov_b32 s40, 2048
    buffer_store_dwordx4 v[152:155], v0, s[28:31], s40 offen sc1
    s_branch L_next2
L_own2:
    v_mov_b32 v136, v32
    v_mov_b32 v137, v33
    v_mov_b32 v138, v34
    v_mov_b32 v139, v35
    v_mov_b32 v140, v36
    v_mov_b32 v141, v37
    v_mov_b32 v142, v38
    v_mov_b32 v143, v39
L_next2:
    s_waitcnt lgkmcnt(8)
    v_accvgpr_read_b32 v132, a72
    v_add_f32 v40, v40, v132
    v_accvgpr_read_b32 v132, a73
    v_add_f32 v41, v41, v132
    v_accvgpr_read_b32 v132, a74
    v_add_f32 v42, v42, v132
    v_accvgpr_read_b32 v132, a75
    v_add_f32 v43, v43, v132
    v_accvgpr_read_b32 v132, a84
    v_add_f32 v44, v44, v132
    v_accvgpr_read_b32 v132, a85
    v_add_f32 v45, v45, v132
    v_accvgpr_read_b32 v132, a86
    v_add_f32 v46, v46, v132
    v_accvgpr_read_b32 v132, a87
    v_add_f32 v47, v47, v132
    s_cmp_eq_u32 s70, 3
    s_cbranch_scc1 L_own3
    v_cvt_pk_bf16_f32 v156, v40, v41
    v_cvt_pk_bf16_f32 v157, v42, v43
    v_cvt_pk_bf16_f32 v158, v44, v45
    v_cvt_pk_bf16_f32 v159, v46, v47
    s_mov_b32 s40, 3072
    buffer_store_dwordx4 v[156:159], v0, s[28:31], s40 offen sc1
    s_branch L_next3
L_own3:
    v_mov_b32 v136, v40
    v_mov_b32 v137, v41
    v_mov_b32 v138, v42
    v_mov_b32 v139, v43
    v_mov_b32 v140, v44
    v_mov_b32 v141, v45
    v_mov_b32 v142, v46
    v_mov_b32 v143, v47
L_next3:
    s_waitcnt lgkmcnt(6)
    v_add_f32 v48, v48, v80
    v_add_f32 v49, v49, v81
    v_add_f32 v50, v50, v82
    v_add_f32 v51, v51, v83
    v_add_f32 v52, v52, v92
    v_add_f32 v53, v53, v93
    v_add_f32 v54, v54, v94
    v_add_f32 v55, v55, v95
    s_cmp_eq_u32 s70, 0
    s_cbranch_scc1 L_own4
    v_cvt_pk_bf16_f32 v152, v48, v49
    v_cvt_pk_bf16_f32 v153, v50, v51
    v_cvt_pk_bf16_f32 v154, v52, v53
    v_cvt_pk_bf16_f32 v155, v54, v55
    s_mov_b32 s40, 4096
    buffer_store_dwordx4 v[152:155], v0, s[28:31], s40 offen sc1
    s_branch L_next4
L_own4:
    v_mov_b32 v144, v48
    v_mov_b32 v145, v49
    v_mov_b32 v146, v50
    v_mov_b32 v147, v51
    v_mov_b32 v148, v52
    v_mov_b32 v149, v53
    v_mov_b32 v150, v54
    v_mov_b32 v151, v55
L_next4:
    s_waitcnt lgkmcnt(4)
    v_accvgpr_read_b32 v132, a4
    v_add_f32 v56, v56, v132
    v_accvgpr_read_b32 v132, a5
    v_add_f32 v57, v57, v132
    v_accvgpr_read_b32 v132, a6
    v_add_f32 v58, v58, v132
    v_accvgpr_read_b32 v132, a7
    v_add_f32 v59, v59, v132
    v_accvgpr_read_b32 v132, a16
    v_add_f32 v60, v60, v132
    v_accvgpr_read_b32 v132, a17
    v_add_f32 v61, v61, v132
    v_accvgpr_read_b32 v132, a18
    v_add_f32 v62, v62, v132
    v_accvgpr_read_b32 v132, a19
    v_add_f32 v63, v63, v132
    s_cmp_eq_u32 s70, 1
    s_cbranch_scc1 L_own5
    v_cvt_pk_bf16_f32 v156, v56, v57
    v_cvt_pk_bf16_f32 v157, v58, v59
    v_cvt_pk_bf16_f32 v158, v60, v61
    v_cvt_pk_bf16_f32 v159, v62, v63
    s_mov_b32 s40, 5120
    buffer_store_dwordx4 v[156:159], v0, s[28:31], s40 offen sc1
    s_branch L_next5
L_own5:
    v_mov_b32 v144, v56
    v_mov_b32 v145, v57
    v_mov_b32 v146, v58
    v_mov_b32 v147, v59
    v_mov_b32 v148, v60
    v_mov_b32 v149, v61
    v_mov_b32 v150, v62
    v_mov_b32 v151, v63
L_next5:
    s_waitcnt lgkmcnt(2)
    v_accvgpr_read_b32 v132, a28
    v_add_f32 v64, v64, v132
    v_accvgpr_read_b32 v132, a29
    v_add_f32 v65, v65, v132
    v_accvgpr_read_b32 v132, a30
    v_add_f32 v66, v66, v132
    v_accvgpr_read_b32 v132, a31
    v_add_f32 v67, v67, v132
    v_accvgpr_read_b32 v132, a40
    v_add_f32 v68, v68, v132
    v_accvgpr_read_b32 v132, a41
    v_add_f32 v69, v69, v132
    v_accvgpr_read_b32 v132, a42
    v_add_f32 v70, v70, v132
    v_accvgpr_read_b32 v132, a43
    v_add_f32 v71, v71, v132
    s_cmp_eq_u32 s70, 2
    s_cbranch_scc1 L_own6
    v_cvt_pk_bf16_f32 v152, v64, v65
    v_cvt_pk_bf16_f32 v153, v66, v67
    v_cvt_pk_bf16_f32 v154, v68, v69
    v_cvt_pk_bf16_f32 v155, v70, v71
    s_mov_b32 s40, 6144
    buffer_store_dwordx4 v[152:155], v0, s[28:31], s40 offen sc1
    s_branch L_next6
L_own6:
    v_mov_b32 v144, v64
    v_mov_b32 v145, v65
    v_mov_b32 v146, v66
    v_mov_b32 v147, v67
    v_mov_b32 v148, v68
    v_mov_b32 v149, v69
    v_mov_b32 v150, v70
    v_mov_b32 v151, v71
L_next6:
    s_waitcnt lgkmcnt(0)
    v_accvgpr_read_b32 v132, a52
    v_add_f32 v72, v72, v132
    v_accvgpr_read_b32 v132, a53
    v_add_f32 v73, v73, v132
    v_accvgpr_read_b32 v132, a54
    v_add_f32 v74, v74, v132
    v_accvgpr_read_b32 v132, a55
    v_add_f32 v75, v75, v132
    v_accvgpr_read_b32 v132, a64
    v_add_f32 v76, v76, v132
    v_accvgpr_read_b32 v132, a65
    v_add_f32 v77, v77, v132
    v_accvgpr_read_b32 v132, a66
    v_add_f32 v78, v78, v132
    v_accvgpr_read_b32 v132, a67
    v_add_f32 v79, v79, v132
    s_cmp_eq_u32 s70, 3
    s_cbranch_scc1 L_own7
    v_cvt_pk_bf16_f32 v156, v72, v73
    v_cvt_pk_bf16_f32 v157, v74, v75
    v_cvt_pk_bf16_f32 v158, v76, v77
    v_cvt_pk_bf16_f32 v159, v78, v79
    s_mov_b32 s40, 7168
    buffer_store_dwordx4 v[156:159], v0, s[28:31], s40 offen sc1
    s_branch L_next7
L_own7:
    v_mov_b32 v144, v72
    v_mov_b32 v145, v73
    v_mov_b32 v146, v74
    v_mov_b32 v147, v75
    v_mov_b32 v148, v76
    v_mov_b32 v149, v77
    v_mov_b32 v150, v78
    v_mov_b32 v151, v79
L_next7:
    s_branch L_red_done
L_red_h1:
    ds_write_b128 v11, a[0:3] offset:0
    ds_write_b128 v11, a[12:15] offset:1024
    ds_write_b128 v11, a[24:27] offset:2048
    ds_write_b128 v11, a[36:39] offset:3072
    ds_write_b128 v11, a[48:51] offset:4096
    ds_write_b128 v11, a[60:63] offset:5120
    ds_write_b128 v11, a[72:75] offset:6144
    ds_write_b128 v11, a[84:87] offset:7168
    ds_write_b128 v11, v[80:83] offset:8192
    ds_write_b128 v11, v[92:95] offset:9216
    ds_write_b128 v11, a[4:7] offset:10240
    ds_write_b128 v11, a[16:19] offset:11264
    ds_write_b128 v11, a[28:31] offset:12288
    ds_write_b128 v11, a[40:43] offset:13312
    ds_write_b128 v11, a[52:55] offset:14336
    ds_write_b128 v11, a[64:67] offset:15360
    s_waitcnt lgkmcnt(0)
    s_barrier
    ds_read_b128 v[16:19], v12 offset:0
    ds_read_b128 v[20:23], v12 offset:1024
    ds_read_b128 v[24:27], v12 offset:2048
    ds_read_b128 v[28:31], v12 offset:3072
    ds_read_b128 v[32:35], v12 offset:4096
    ds_read_b128 v[36:39], v12 offset:5120
    ds_read_b128 v[40:43], v12 offset:6144
    ds_read_b128 v[44:47], v12 offset:7168
    ds_read_b128 v[48:51], v12 offset:8192
    ds_read_b128 v[52:55], v12 offset:9216
    ds_read_b128 v[56:59], v12 offset:10240
    ds_read_b128 v[60:63], v12 offset:11264
    ds_read_b128 v[64:67], v12 offset:12288
    ds_read_b128 v[68:71], v12 offset:13312
    s_waitcnt lgkmcnt(12)
    v_accvgpr_read_b32 v132, a76
    v_add_f32 v16, v16, v132
    v_accvgpr_read_b32 v132, a77
    v_add_f32 v17, v17, v132
    v_accvgpr_read_b32 v132, a78
    v_add_f32 v18, v18, v132
    v_accvgpr_read_b32 v132, a79
    v_add_f32 v19, v19, v132
    v_accvgpr_read_b32 v132, a88
    v_add_f32 v20, v20, v132
    v_accvgpr_read_b32 v132, a89
    v_add_f32 v21, v21, v132
    v_accvgpr_read_b32 v132, a90
    v_add_f32 v22, v22, v132
    v_accvgpr_read_b32 v132, a91
    v_add_f32 v23, v23, v132
    s_cmp_eq_u32 s70, 0
    s_cbranch_scc1 L_own8
    v_cvt_pk_bf16_f32 v152, v16, v17
    v_cvt_pk_bf16_f32 v153, v18, v19
    v_cvt_pk_bf16_f32 v154, v20, v21
    v_cvt_pk_bf16_f32 v155, v22, v23
    s_mov_b32 s40, 8192
    buffer_store_dwordx4 v[152:155], v0, s[28:31], s40 offen sc1
    s_branch L_next8
L_own8:
    v_mov_b32 v136, v16
    v_mov_b32 v137, v17
    v_mov_b32 v138, v18
    v_mov_b32 v139, v19
    v_mov_b32 v140, v20
    v_mov_b32 v141, v21
    v_mov_b32 v142, v22
    v_mov_b32 v143, v23
L_next8:
    s_waitcnt lgkmcnt(10)
    v_add_f32 v24, v24, v84
    v_add_f32 v25, v25, v85
    v_add_f32 v26, v26, v86
    v_add_f32 v27, v27, v87
    v_add_f32 v28, v28, v96
    v_add_f32 v29, v29, v97
    v_add_f32 v30, v30, v98
    v_add_f32 v31, v31, v99
    s_cmp_eq_u32 s70, 1
    s_cbranch_scc1 L_own9
    v_cvt_pk_bf16_f32 v156, v24, v25
    v_cvt_pk_bf16_f32 v157, v26, v27
    v_cvt_pk_bf16_f32 v158, v28, v29
    v_cvt_pk_bf16_f32 v159, v30, v31
    s_mov_b32 s40, 9216
    buffer_store_dwordx4 v[156:159], v0, s[28:31], s40 offen sc1
    s_branch L_next9
L_own9:
    v_mov_b32 v136, v24
    v_mov_b32 v137, v25
    v_mov_b32 v138, v26
    v_mov_b32 v139, v27
    v_mov_b32 v140, v28
    v_mov_b32 v141, v29
    v_mov_b32 v142, v30
    v_mov_b32 v143, v31
L_next9:
    s_waitcnt lgkmcnt(8)
    v_accvgpr_read_b32 v132, a8
    v_add_f32 v32, v32, v132
    v_accvgpr_read_b32 v132, a9
    v_add_f32 v33, v33, v132
    v_accvgpr_read_b32 v132, a10
    v_add_f32 v34, v34, v132
    v_accvgpr_read_b32 v132, a11
    v_add_f32 v35, v35, v132
    v_accvgpr_read_b32 v132, a20
    v_add_f32 v36, v36, v132
    v_accvgpr_read_b32 v132, a21
    v_add_f32 v37, v37, v132
    v_accvgpr_read_b32 v132, a22
    v_add_f32 v38, v38, v132
    v_accvgpr_read_b32 v132, a23
    v_add_f32 v39, v39, v132
    s_cmp_eq_u32 s70, 2
    s_cbranch_scc1 L_own10
    v_cvt_pk_bf16_f32 v152, v32, v33
    v_cvt_pk_bf16_f32 v153, v34, v35
    v_cvt_pk_bf16_f32 v154, v36, v37
    v_cvt_pk_bf16_f32 v155, v38, v39
    s_mov_b32 s40, 10240
    buffer_store_dwordx4 v[152:155], v0, s[28:31], s40 offen sc1
    s_branch L_next10
L_own10:
    v_mov_b32 v136, v32
    v_mov_b32 v137, v33
    v_mov_b32 v138, v34
    v_mov_b32 v139, v35
    v_mov_b32 v140, v36
    v_mov_b32 v141, v37
    v_mov_b32 v142, v38
    v_mov_b32 v143, v39
L_next10:
    s_waitcnt lgkmcnt(6)
    v_accvgpr_read_b32 v132, a32
    v_add_f32 v40, v40, v132
    v_accvgpr_read_b32 v132, a33
    v_add_f32 v41, v41, v132
    v_accvgpr_read_b32 v132, a34
    v_add_f32 v42, v42, v132
    v_accvgpr_read_b32 v132, a35
    v_add_f32 v43, v43, v132
    v_accvgpr_read_b32 v132, a44
    v_add_f32 v44, v44, v132
    v_accvgpr_read_b32 v132, a45
    v_add_f32 v45, v45, v132
    v_accvgpr_read_b32 v132, a46
    v_add_f32 v46, v46, v132
    v_accvgpr_read_b32 v132, a47
    v_add_f32 v47, v47, v132
    s_cmp_eq_u32 s70, 3
    s_cbranch_scc1 L_own11
    v_cvt_pk_bf16_f32 v156, v40, v41
    v_cvt_pk_bf16_f32 v157, v42, v43
    v_cvt_pk_bf16_f32 v158, v44, v45
    v_cvt_pk_bf16_f32 v159, v46, v47
    s_mov_b32 s40, 11264
    buffer_store_dwordx4 v[156:159], v0, s[28:31], s40 offen sc1
    s_branch L_next11
L_own11:
    v_mov_b32 v136, v40
    v_mov_b32 v137, v41
    v_mov_b32 v138, v42
    v_mov_b32 v139, v43
    v_mov_b32 v140, v44
    v_mov_b32 v141, v45
    v_mov_b32 v142, v46
    v_mov_b32 v143, v47
L_next11:
    s_waitcnt lgkmcnt(4)
    v_accvgpr_read_b32 v132, a56
    v_add_f32 v48, v48, v132
    v_accvgpr_read_b32 v132, a57
    v_add_f32 v49, v49, v132
    v_accvgpr_read_b32 v132, a58
    v_add_f32 v50, v50, v132
    v_accvgpr_read_b32 v132, a59
    v_add_f32 v51, v51, v132
    v_accvgpr_read_b32 v132, a68
    v_add_f32 v52, v52, v132
    v_accvgpr_read_b32 v132, a69
    v_add_f32 v53, v53, v132
    v_accvgpr_read_b32 v132, a70
    v_add_f32 v54, v54, v132
    v_accvgpr_read_b32 v132, a71
    v_add_f32 v55, v55, v132
    s_cmp_eq_u32 s70, 0
    s_cbranch_scc1 L_own12
    v_cvt_pk_bf16_f32 v152, v48, v49
    v_cvt_pk_bf16_f32 v153, v50, v51
    v_cvt_pk_bf16_f32 v154, v52, v53
    v_cvt_pk_bf16_f32 v155, v54, v55
    s_mov_b32 s40, 12288
    buffer_store_dwordx4 v[152:155], v0, s[28:31], s40 offen sc1
    s_branch L_next12
L_own12:
    v_mov_b32 v144, v48
    v_mov_b32 v145, v49
    v_mov_b32 v146, v50
    v_mov_b32 v147, v51
    v_mov_b32 v148, v52
    v_mov_b32 v149, v53
    v_mov_b32 v150, v54
    v_mov_b32 v151, v55
L_next12:
    s_waitcnt lgkmcnt(2)
    v_accvgpr_read_b32 v132, a80
    v_add_f32 v56, v56, v132
    v_accvgpr_read_b32 v132, a81
    v_add_f32 v57, v57, v132
    v_accvgpr_read_b32 v132, a82
    v_add_f32 v58, v58, v132
    v_accvgpr_read_b32 v132, a83
    v_add_f32 v59, v59, v132
    v_accvgpr_read_b32 v132, a92
    v_add_f32 v60, v60, v132
    v_accvgpr_read_b32 v132, a93
    v_add_f32 v61, v61, v132
    v_accvgpr_read_b32 v132, a94
    v_add_f32 v62, v62, v132
    v_accvgpr_read_b32 v132, a95
    v_add_f32 v63, v63, v132
    s_cmp_eq_u32 s70, 1
    s_cbranch_scc1 L_own13
    v_cvt_pk_bf16_f32 v156, v56, v57
    v_cvt_pk_bf16_f32 v157, v58, v59
    v_cvt_pk_bf16_f32 v158, v60, v61
    v_cvt_pk_bf16_f32 v159, v62, v63
    s_mov_b32 s40, 13312
    buffer_store_dwordx4 v[156:159], v0, s[28:31], s40 offen sc1
    s_branch L_next13
L_own13:
    v_mov_b32 v144, v56
    v_mov_b32 v145, v57
    v_mov_b32 v146, v58
    v_mov_b32 v147, v59
    v_mov_b32 v148, v60
    v_mov_b32 v149, v61
    v_mov_b32 v150, v62
    v_mov_b32 v151, v63
L_next13:
    s_waitcnt lgkmcnt(0)
    v_add_f32 v64, v64, v88
    v_add_f32 v65, v65, v89
    v_add_f32 v66, v66, v90
    v_add_f32 v67, v67, v91
    v_add_f32 v68, v68, v100
    v_add_f32 v69, v69, v101
    v_add_f32 v70, v70, v102
    v_add_f32 v71, v71, v103
    s_cmp_eq_u32 s70, 2
    s_cbranch_scc1 L_own14
    v_cvt_pk_bf16_f32 v152, v64, v65
    v_cvt_pk_bf16_f32 v153, v66, v67
    v_cvt_pk_bf16_f32 v154, v68, v69
    v_cvt_pk_bf16_f32 v155, v70, v71
    s_mov_b32 s40, 14336
    buffer_store_dwordx4 v[152:155], v0, s[28:31], s40 offen sc1
    s_branch L_next14
L_own14:
    v_mov_b32 v144, v64
    v_mov_b32 v145, v65
    v_mov_b32 v146, v66
    v_mov_b32 v147, v67
    v_mov_b32 v148, v68
    v_mov_b32 v149, v69
    v_mov_b32 v150, v70
    v_mov_b32 v151, v71
L_next14:
L_red_done:
    s_waitcnt vmcnt(0)
    s_barrier
    s_cmp_eq_u32 s3, 0
    s_cbranch_scc0 L_fin_skip
    s_lshl_b32 s40, s79, 2
    s_mov_b64 exec, 1
    v_mov_b32 v11, s40
    v_mov_b32 v12, 524288
    global_atomic_add v11, v12, s[62:63]
    s_mov_b64 exec, -1
    s_lshl_b32 s40, s79, 2
    v_mov_b32 v11, s40
L_pollf:
    global_load_dword v12, v11, s[62:63] sc1
    s_waitcnt vmcnt(0)
    v_readfirstlane_b32 s41, v12
    s_nop 2
    s_bfe_u32 s41, s41, 196627
    s_cmp_eq_u32 s41, 4
    s_cbranch_scc1 L_pollf_done
    s_sleep 1
    s_branch L_pollf
L_pollf_done:
L_fin_skip:
    s_lshl_b32 s40, s79, 2
    s_mul_i32 s40, s40, 61440
    s_add_u32 s40, s40, 33554432
    s_mul_i32 s41, s74, 15360
    s_add_u32 s41, s41, s40
    s_add_u32 s28, s60, s41
    s_addc_u32 s29, s61, 0
    s_mov_b32 s30, 199680
    s_mov_b32 s31, 0x20000
    s_mov_b32 s32, s56
    s_mov_b32 s33, s57
    s_mov_b32 s34, 3932160
    s_mov_b32 s35, 0x20000
    v_lshrrev_b32 v12, 4, v0
    v_and_b32 v13, 15, v12
    v_lshrrev_b32 v14, 4, v12
    s_mul_i32 s40, s7, 192
    s_mul_i32 s41, s74, 48
    s_add_u32 s40, s40, s41
    v_add_u32 v13, s40, v13
    v_mul_u32_u24 v13, 2560, v13
    s_mul_i32 s40, s6, 640
    s_mul_i32 s41, s10, 160
    s_add_u32 s40, s40, s41
    s_lshl_b32 s40, s40, 1
    v_lshl_add_u32 v13, v14, 3, v13
    v_add_u32 v13, s40, v13
    s_lshl_b32 s71, s4, 3
    s_add_u32 s71, s71, s70
    s_barrier
    s_add_u32 s42, s71, 0
    s_lshl_b32 s43, s42, 10
    s_add_u32 s46, s8, 1
    s_and_b32 s46, s46, 3
    s_mul_i32 s46, s46, 61440
    s_add_u32 s46, s46, s43
    buffer_load_dwordx4 v[16:19], v0, s[28:31], s46 offen sc1
    s_add_u32 s46, s8, 2
    s_and_b32 s46, s46, 3
    s_mul_i32 s46, s46, 61440
    s_add_u32 s46, s46, s43
    buffer_load_dwordx4 v[20:23], v0, s[28:31], s46 offen sc1
    s_add_u32 s46, s8, 3
    s_and_b32 s46, s46, 3
    s_mul_i32 s46, s46, 61440
    s_add_u32 s46, s46, s43
    buffer_load_dwordx4 v[24:27], v0, s[28:31], s46 offen sc1
    s_add_u32 s42, s71, 4
    s_lshl_b32 s43, s42, 10
    s_add_u32 s46, s8, 1
    s_and_b32 s46, s46, 3
    s_mul_i32 s46, s46, 61440
    s_add_u32 s46, s46, s43
    buffer_load_dwordx4 v[28:31], v0, s[28:31], s46 offen sc1
    s_add_u32 s46, s8, 2
    s_and_b32 s46, s46, 3
    s_mul_i32 s46, s46, 61440
    s_add_u32 s46, s46, s43
    buffer_load_dwordx4 v[32:35], v0, s[28:31], s46 offen sc1
    s_add_u32 s46, s8, 3
    s_and_b32 s46, s46, 3
    s_mul_i32 s46, s46, 61440
    s_add_u32 s46, s46, s43
    buffer_load_dwordx4 v[36:39], v0, s[28:31], s46 offen sc1
    s_waitcnt vmcnt(3)
    v_lshlrev_b32 v88, 16, v16
    v_add_f32 v136, v136, v88
    v_lshlrev_b32 v88, 16, v20
    v_add_f32 v136, v136, v88
    v_lshlrev_b32 v88, 16, v24
    v_add_f32 v136, v136, v88
    v_and_b32 v88, 0xffff0000, v16
    v_add_f32 v137, v137, v88
    v_and_b32 v88, 0xffff0000, v20
    v_add_f32 v137, v137, v88
    v_and_b32 v88, 0xffff0000, v24
    v_add_f32 v137, v137, v88
    v_lshlrev_b32 v88, 16, v17
    v_add_f32 v138, v138, v88
    v_lshlrev_b32 v88, 16, v21
    v_add_f32 v138, v138, v88
    v_lshlrev_b32 v88, 16, v25
    v_add_f32 v138, v138, v88
    v_and_b32 v88, 0xffff0000, v17
    v_add_f32 v139, v139, v88
    v_and_b32 v88, 0xffff0000, v21
    v_add_f32 v139, v139, v88
    v_and_b32 v88, 0xffff0000, v25
    v_add_f32 v139, v139, v88
    v_lshlrev_b32 v88, 16, v18
    v_add_f32 v140, v140, v88
    v_lshlrev_b32 v88, 16, v22
    v_add_f32 v140, v140, v88
    v_lshlrev_b32 v88, 16, v26
    v_add_f32 v140, v140, v88
    v_and_b32 v88, 0xffff0000, v18
    v_add_f32 v141, v141, v88
    v_and_b32 v88, 0xffff0000, v22
    v_add_f32 v141, v141, v88
    v_and_b32 v88, 0xffff0000, v26
    v_add_f32 v141, v141, v88
    v_lshlrev_b32 v88, 16, v19
    v_add_f32 v142, v142, v88
    v_lshlrev_b32 v88, 16, v23
    v_add_f32 v142, v142, v88
    v_lshlrev_b32 v88, 16, v27
    v_add_f32 v142, v142, v88
    v_and_b32 v88, 0xffff0000, v19
    v_add_f32 v143, v143, v88
    v_and_b32 v88, 0xffff0000, v23
    v_add_f32 v143, v143, v88
    v_and_b32 v88, 0xffff0000, v27
    v_add_f32 v143, v143, v88
    v_cvt_pk_bf16_f32 v90, v136, v137
    v_cvt_pk_bf16_f32 v91, v138, v139
    v_cvt_pk_bf16_f32 v92, v140, v141
    v_cvt_pk_bf16_f32 v93, v142, v143
    s_add_u32 s42, s71, 0
    s_mul_i32 s43, s42, 52
    s_lshr_b32 s43, s43, 8
    s_mul_i32 s46, s43, 5
    s_sub_u32 s46, s42, s46
    s_lshl_b32 s46, s46, 6
    s_mul_i32 s43, s43, 40960
    s_add_u32 s46, s46, s43
    buffer_store_dwordx2 v[90:91], v13, s[32:35], s46 offen
    buffer_store_dwordx2 v[92:93], v13, s[32:35], s46 offen offset:32
    s_add_u32 s42, s71, 4
    s_cmp_ge_u32 s42, 15
    s_cbranch_scc1 L_tail_end
    s_waitcnt vmcnt(2)
    v_lshlrev_b32 v88, 16, v28
    v_add_f32 v144, v144, v88
    v_lshlrev_b32 v88, 16, v32
    v_add_f32 v144, v144, v88
    v_lshlrev_b32 v88, 16, v36
    v_add_f32 v144, v144, v88
    v_and_b32 v88, 0xffff0000, v28
    v_add_f32 v145, v145, v88
    v_and_b32 v88, 0xffff0000, v32
    v_add_f32 v145, v145, v88
    v_and_b32 v88, 0xffff0000, v36
    v_add_f32 v145, v145, v88
    v_lshlrev_b32 v88, 16, v29
    v_add_f32 v146, v146, v88
    v_lshlrev_b32 v88, 16, v33
    v_add_f32 v146, v146, v88
    v_lshlrev_b32 v88, 16, v37
    v_add_f32 v146, v146, v88
    v_and_b32 v88, 0xffff0000, v29
    v_add_f32 v147, v147, v88
    v_and_b32 v88, 0xffff0000, v33
    v_add_f32 v147, v147, v88
    v_and_b32 v88, 0xffff0000, v37
    v_add_f32 v147, v147, v88
    v_lshlrev_b32 v88, 16, v30
    v_add_f32 v148, v148, v88
    v_lshlrev_b32 v88, 16, v34
    v_add_f32 v148, v148, v88
    v_lshlrev_b32 v88, 16, v38
    v_add_f32 v148, v148, v88
    v_and_b32 v88, 0xffff0000, v30
    v_add_f32 v149, v149, v88
    v_and_b32 v88, 0xffff0000, v34
    v_add_f32 v149, v149, v88
    v_and_b32 v88, 0xffff0000, v38
    v_add_f32 v149, v149, v88
    v_lshlrev_b32 v88, 16, v31
    v_add_f32 v150, v150, v88
    v_lshlrev_b32 v88, 16, v35
    v_add_f32 v150, v150, v88
    v_lshlrev_b32 v88, 16, v39
    v_add_f32 v150, v150, v88
    v_and_b32 v88, 0xffff0000, v31
    v_add_f32 v151, v151, v88
    v_and_b32 v88, 0xffff0000, v35
    v_add_f32 v151, v151, v88
    v_and_b32 v88, 0xffff0000, v39
    v_add_f32 v151, v151, v88
    v_cvt_pk_bf16_f32 v90, v144, v145
    v_cvt_pk_bf16_f32 v91, v146, v147
    v_cvt_pk_bf16_f32 v92, v148, v149
    v_cvt_pk_bf16_f32 v93, v150, v151
    s_add_u32 s42, s71, 4
    s_mul_i32 s43, s42, 52
    s_lshr_b32 s43, s43, 8
    s_mul_i32 s46, s43, 5
    s_sub_u32 s46, s42, s46
    s_lshl_b32 s46, s46, 6
    s_mul_i32 s43, s43, 40960
    s_add_u32 s46, s46, s43
    buffer_store_dwordx2 v[90:91], v13, s[32:35], s46 offen
    buffer_store_dwordx2 v[92:93], v13, s[32:35], s46 offen offset:32
L_tail_end:
    s_waitcnt vmcnt(0)
    s_branch L_fin
L_slow:
    s_waitcnt vmcnt(0)
    s_barrier
    s_mov_b32 s48, s58
    s_mov_b32 s49, s59
    s_mov_b32 s50, 0
    s_mov_b32 s51, 0x20000
    s_mov_b32 s73, 1
    v_subrev_u32 v1, s42, v1
    v_subrev_u32 v2, s42, v2
    v_subrev_u32 v3, s42, v3
    v_subrev_u32 v4, s42, v4
    v_subrev_u32 v5, s43, v5
    v_subrev_u32 v6, s43, v6
    s_mov_b32 s18, 0
    s_mov_b32 s19, 0
    s_mov_b32 s13, 0
    v_mov_b32 v52, 0xff800000
    v_mov_b32 v53, 0xff800000
    v_mov_b32 v54, 0xff800000
    s_mov_b32 s72, 0
L_max_loop:
    s_mov_b32 s16, 0
    s_add_u32 s14, s18, s13
    s_and_b32 s14, s14, 15
    s_lshl_b32 s14, s14, 13
    s_cmp_lt_u32 s18, 16
    s_cselect_b32 s14, s14, 2130706432
    s_add_u32 s18, s18, 1
    s_add_u32 m0, s76, s16
    s_nop 0
    buffer_load_dwordx4 v7, s[28:31], s14 offen nt lds
    s_add_u32 m0, s76, s16
    s_add_u32 m0, m0, 1024
    s_add_u32 s16, s16, 8192
    s_cmp_eq_u32 s16, 24576
    s_cselect_b32 s16, 0, s16
    buffer_load_dwordx4 v8, s[28:31], s14 offen nt lds
    s_waitcnt vmcnt(0)
    s_barrier
    ds_read_b128 v[16:19], v1 offset:0
    ds_read_b128 v[20:23], v2 offset:0
    ds_read_b128 v[24:27], v3 offset:0
    ds_read_b128 v[28:31], v4 offset:0
    s_waitcnt lgkmcnt(3)
    v_mfma_f32_16x16x32_bf16 v[64:67], v[16:19], v[112:115], 0
    ds_read_b128 v[32:35], v1 offset:4096
    v_mfma_f32_16x16x32_bf16 v[68:71], v[16:19], v[128:131], 0
    v_mfma_f32_16x16x32_bf16 v[72:75], v[16:19], v[144:147], 0
    s_waitcnt lgkmcnt(3)
    v_mfma_f32_16x16x32_bf16 v[64:67], v[20:23], v[116:119], v[64:67]
    ds_read_b128 v[16:19], v2 offset:4096
    v_mfma_f32_16x16x32_bf16 v[68:71], v[20:23], v[132:135], v[68:71]
    v_mfma_f32_16x16x32_bf16 v[72:75], v[20:23], v[148:151], v[72:75]
    s_waitcnt lgkmcnt(3)
    v_mfma_f32_16x16x32_bf16 v[64:67], v[24:27], v[120:123], v[64:67]
    ds_read_b128 v[20:23], v3 offset:4096
    v_mfma_f32_16x16x32_bf16 v[68:71], v[24:27], v[136:139], v[68:71]
    v_mfma_f32_16x16x32_bf16 v[72:75], v[24:27], v[152:155], v[72:75]
    s_waitcnt lgkmcnt(3)
    v_mfma_f32_16x16x32_bf16 v[64:67], v[28:31], v[124:127], v[64:67]
    ds_read_b128 v[24:27], v4 offset:4096
    v_mfma_f32_16x16x32_bf16 v[68:71], v[28:31], v[140:143], v[68:71]
    v_mfma_f32_16x16x32_bf16 v[72:75], v[28:31], v[156:159], v[72:75]
    s_waitcnt lgkmcnt(3)
    v_mfma_f32_16x16x32_bf16 v[76:79], v[32:35], v[112:115], 0
    v_mfma_f32_16x16x32_bf16 v[80:83], v[32:35], v[128:131], 0
    v_mfma_f32_16x16x32_bf16 v[84:87], v[32:35], v[144:147], 0
    s_waitcnt lgkmcnt(2)
    v_mfma_f32_16x16x32_bf16 v[76:79], v[16:19], v[116:119], v[76:79]
    v_mfma_f32_16x16x32_bf16 v[80:83], v[16:19], v[132:135], v[80:83]
    v_mfma_f32_16x16x32_bf16 v[84:87], v[16:19], v[148:151], v[84:87]
    s_waitcnt lgkmcnt(1)
    v_mfma_f32_16x16x32_bf16 v[76:79], v[20:23], v[120:123], v[76:79]
    v_mfma_f32_16x16x32_bf16 v[80:83], v[20:23], v[136:139], v[80:83]
    v_mfma_f32_16x16x32_bf16 v[84:87], v[20:23], v[152:155], v[84:87]
    s_waitcnt lgkmcnt(0)
    v_mfma_f32_16x16x32_bf16 v[76:79], v[24:27], v[124:127], v[76:79]
    v_mfma_f32_16x16x32_bf16 v[80:83], v[24:27], v[140:143], v[80:83]
    v_mfma_f32_16x16x32_bf16 v[84:87], v[24:27], v[156:159], v[84:87]
    v_max3_f32 v52, v52, v64, v65
    v_max3_f32 v52, v52, v66, v67
    s_nop 3
    v_max3_f32 v52, v52, v76, v77
    v_max3_f32 v52, v52, v78, v79
    v_max3_f32 v53, v53, v68, v69
    v_max3_f32 v53, v53, v70, v71
    v_max3_f32 v53, v53, v80, v81
    v_max3_f32 v53, v53, v82, v83
    v_max3_f32 v54, v54, v72, v73
    v_max3_f32 v54, v54, v74, v75
    v_max3_f32 v54, v54, v84, v85
    v_max3_f32 v54, v54, v86, v87
    s_barrier
    s_add_u32 s72, s72, 1
    s_cmp_lt_u32 s72, 16
    s_cbranch_scc1 L_max_loop
    v_mov_b32 v56, v52
    v_mov_b32 v57, v53
    v_mov_b32 v58, v54
    v_permlane16_swap_b32 v52, v56
    v_permlane16_swap_b32 v53, v57
    v_permlane16_swap_b32 v54, v58
    v_max_f32 v52, v52, v56
    v_max_f32 v53, v53, v57
    v_max_f32 v54, v54, v58
    v_mov_b32 v56, v52
    v_mov_b32 v57, v53
    v_mov_b32 v58, v54
    v_permlane32_swap_b32 v52, v56
    v_permlane32_swap_b32 v53, v57
    v_permlane32_swap_b32 v54, v58
    v_max_f32 v52, v52, v56
    v_max_f32 v53, v53, v57
    v_max_f32 v54, v54, v58
    v_sub_f32 v40, 0, v52
    v_sub_f32 v41, 0, v52
    v_sub_f32 v42, 0, v52
    v_sub_f32 v43, 0, v52
    v_sub_f32 v44, 0, v53
    v_sub_f32 v45, 0, v53
    v_sub_f32 v46, 0, v53
    v_sub_f32 v47, 0, v53
    v_sub_f32 v48, 0, v54
    v_sub_f32 v49, 0, v54
    v_sub_f32 v50, 0, v54
    v_sub_f32 v51, 0, v54
    s_mov_b32 s18, 0
    s_mov_b32 s19, 0
    s_mov_b32 s16, 0
    s_mov_b32 s17, 0
    s_add_u32 s14, s18, s13
    s_and_b32 s14, s14, 15
    s_lshl_b32 s14, s14, 13
    s_cmp_lt_u32 s18, 16
    s_cselect_b32 s14, s14, 2130706432
    s_add_u32 s18, s18, 1
    s_add_u32 m0, s76, s16
    s_nop 0
    buffer_load_dwordx4 v7, s[28:31], s14 offen nt lds
    s_add_u32 m0, s76, s16
    s_add_u32 m0, m0, 1024
    s_add_u32 s16, s16, 8192
    s_cmp_eq_u32 s16, 24576
    s_cselect_b32 s16, 0, s16
    buffer_load_dwordx4 v8, s[28:31], s14 offen nt lds
    s_add_u32 s14, s18, s13
    s_and_b32 s14, s14, 15
    s_lshl_b32 s14, s14, 13
    s_cmp_lt_u32 s18, 16
    s_cselect_b32 s14, s14, 2130706432
    s_add_u32 s18, s18, 1
    s_add_u32 m0, s76, s16
    s_nop 0
    buffer_load_dwordx4 v7, s[28:31], s14 offen nt lds
    s_add_u32 m0, s76, s16
    s_add_u32 m0, m0, 1024
    s_add_u32 s16, s16, 8192
    s_cmp_eq_u32 s16, 24576
    s_cselect_b32 s16, 0, s16
    buffer_load_dwordx4 v8, s[28:31], s14 offen nt lds
    s_add_u32 s15, s19, s13
    s_and_b32 s15, s15, 15
    s_lshl_b32 s15, s15, 13
    s_cmp_lt_u32 s19, 16
    s_cselect_b32 s15, s15, 2130706432
    s_add_u32 s19, s19, 1
    s_add_u32 m0, s77, s17
    s_nop 0
    buffer_load_dwordx4 v9, s[32:35], s15 offen nt lds
    s_add_u32 m0, s77, s17
    s_add_u32 m0, m0, 1024
    s_add_u32 s17, s17, 8192
    s_cmp_eq_u32 s17, 24576
    s_cselect_b32 s17, 0, s17
    buffer_load_dwordx4 v10, s[32:35], s15 offen nt lds
    s_add_u32 s14, s18, s13
    s_and_b32 s14, s14, 15
    s_lshl_b32 s14, s14, 13
    s_cmp_lt_u32 s18, 16
    s_cselect_b32 s14, s14, 2130706432
    s_add_u32 s18, s18, 1
    s_add_u32 m0, s76, s16
    s_nop 0
    buffer_load_dwordx4 v7, s[28:31], s14 offen nt lds
    s_add_u32 m0, s76, s16
    s_add_u32 m0, m0, 1024
    s_add_u32 s16, s16, 8192
    s_cmp_eq_u32 s16, 24576
    s_cselect_b32 s16, 0, s16
    buffer_load_dwordx4 v8, s[28:31], s14 offen nt lds
    s_add_u32 s15, s19, s13
    s_and_b32 s15, s15, 15
    s_lshl_b32 s15, s15, 13
    s_cmp_lt_u32 s19, 16
    s_cselect_b32 s15, s15, 2130706432
    s_add_u32 s19, s19, 1
    s_add_u32 m0, s77, s17
    s_nop 0
    buffer_load_dwordx4 v9, s[32:35], s15 offen nt lds
    s_add_u32 m0, s77, s17
    s_add_u32 m0, m0, 1024
    s_add_u32 s17, s17, 8192
    s_cmp_eq_u32 s17, 24576
    s_cselect_b32 s17, 0, s17
    buffer_load_dwordx4 v10, s[32:35], s15 offen nt lds
    v_accvgpr_write_b32 a0, 0
    v_accvgpr_write_b32 a1, 0
    v_accvgpr_write_b32 a2, 0
    v_accvgpr_write_b32 a3, 0
    v_accvgpr_write_b32 a4, 0
    v_accvgpr_write_b32 a5, 0
    v_accvgpr_write_b32 a6, 0
    v_accvgpr_write_b32 a7, 0
    v_accvgpr_write_b32 a8, 0
    v_accvgpr_write_b32 a9, 0
    v_accvgpr_write_b32 a10, 0
    v_accvgpr_write_b32 a11, 0
    v_accvgpr_write_b32 a12, 0
    v_accvgpr_write_b32 a13, 0
    v_accvgpr_write_b32 a14, 0
    v_accvgpr_write_b32 a15, 0
    v_accvgpr_write_b32 a16, 0
    v_accvgpr_write_b32 a17, 0
    v_accvgpr_write_b32 a18, 0
    v_accvgpr_write_b32 a19, 0
    v_accvgpr_write_b32 a20, 0
    v_accvgpr_write_b32 a21, 0
    v_accvgpr_write_b32 a22, 0
    v_accvgpr_write_b32 a23, 0
    v_accvgpr_write_b32 a24, 0
    v_accvgpr_write_b32 a25, 0
    v_accvgpr_write_b32 a26, 0
    v_accvgpr_write_b32 a27, 0
    v_accvgpr_write_b32 a28, 0
    v_accvgpr_write_b32 a29, 0
    v_accvgpr_write_b32 a30, 0
    v_accvgpr_write_b32 a31, 0
    v_accvgpr_write_b32 a32, 0
    v_accvgpr_write_b32 a33, 0
    v_accvgpr_write_b32 a34, 0
    v_accvgpr_write_b32 a35, 0
    v_accvgpr_write_b32 a36, 0
    v_accvgpr_write_b32 a37, 0
    v_accvgpr_write_b32 a38, 0
    v_accvgpr_write_b32 a39, 0
    v_accvgpr_write_b32 a40, 0
    v_accvgpr_write_b32 a41, 0
    v_accvgpr_write_b32 a42, 0
    v_accvgpr_write_b32 a43, 0
    v_accvgpr_write_b32 a44, 0
    v_accvgpr_write_b32 a45, 0
    v_accvgpr_write_b32 a46, 0
    v_accvgpr_write_b32 a47, 0
    v_accvgpr_write_b32 a48, 0
    v_accvgpr_write_b32 a49, 0
    v_accvgpr_write_b32 a50, 0
    v_accvgpr_write_b32 a51, 0
    v_accvgpr_write_b32 a52, 0
    v_accvgpr_write_b32 a53, 0
    v_accvgpr_write_b32 a54, 0
    v_accvgpr_write_b32 a55, 0
    v_accvgpr_write_b32 a56, 0
    v_accvgpr_write_b32 a57, 0
    v_accvgpr_write_b32 a58, 0
    v_accvgpr_write_b32 a59, 0
    v_accvgpr_write_b32 a60, 0
    v_accvgpr_write_b32 a61, 0
    v_accvgpr_write_b32 a62, 0
    v_accvgpr_write_b32 a63, 0
    v_accvgpr_write_b32 a64, 0
    v_accvgpr_write_b32 a65, 0
    v_accvgpr_write_b32 a66, 0
    v_accvgpr_write_b32 a67, 0
    v_accvgpr_write_b32 a68, 0
    v_accvgpr_write_b32 a69, 0
    v_accvgpr_write_b32 a70, 0
    v_accvgpr_write_b32 a71, 0
    v_accvgpr_write_b32 a72, 0
    v_accvgpr_write_b32 a73, 0
    v_accvgpr_write_b32 a74, 0
    v_accvgpr_write_b32 a75, 0
    v_accvgpr_write_b32 a76, 0
    v_accvgpr_write_b32 a77, 0
    v_accvgpr_write_b32 a78, 0
    v_accvgpr_write_b32 a79, 0
    v_accvgpr_write_b32 a80, 0
    v_accvgpr_write_b32 a81, 0
    v_accvgpr_write_b32 a82, 0
    v_accvgpr_write_b32 a83, 0
    v_accvgpr_write_b32 a84, 0
    v_accvgpr_write_b32 a85, 0
    v_accvgpr_write_b32 a86, 0
    v_accvgpr_write_b32 a87, 0
    v_accvgpr_write_b32 a88, 0
    v_accvgpr_write_b32 a89, 0
    v_accvgpr_write_b32 a90, 0
    v_accvgpr_write_b32 a91, 0
    v_accvgpr_write_b32 a92, 0
    v_accvgpr_write_b32 a93, 0
    v_accvgpr_write_b32 a94, 0
    v_accvgpr_write_b32 a95, 0
    v_mov_b32 v13, 0
    v_mov_b32 v14, 0
    v_mov_b32 v15, 0
    s_waitcnt vmcnt(8)
    s_barrier
    ds_read_b128 v[16:19], v1 offset:0
    ds_read_b128 v[20:23], v2 offset:0
    ds_read_b128 v[24:27], v3 offset:0
    ds_read_b128 v[28:31], v4 offset:0
    s_waitcnt lgkmcnt(3)
    v_mfma_f32_16x16x32_bf16 v[64:67], v[16:19], v[112:115], v[40:43]
    ds_read_b128 v[32:35], v1 offset:4096
    v_mfma_f32_16x16x32_bf16 v[68:71], v[16:19], v[128:131], v[44:47]
    v_mfma_f32_16x16x32_bf16 v[72:75], v[16:19], v[144:147], v[48:51]
    s_waitcnt lgkmcnt(3)
    v_mfma_f32_16x16x32_bf16 v[64:67], v[20:23], v[116:119], v[64:67]
    ds_read_b128 v[16:19], v2 offset:4096
    v_mfma_f32_16x16x32_bf16 v[68:71], v[20:23], v[132:135], v[68:71]
    v_mfma_f32_16x16x32_bf16 v[72:75], v[20:23], v[148:151], v[72:75]
    s_waitcnt lgkmcnt(3)
    v_mfma_f32_16x16x32_bf16 v[64:67], v[24:27], v[120:123], v[64:67]
    ds_read_b128 v[20:23], v3 offset:4096
    v_mfma_f32_16x16x32_bf16 v[68:71], v[24:27], v[136:139], v[68:71]
    v_mfma_f32_16x16x32_bf16 v[72:75], v[24:27], v[152:155], v[72:75]
    s_waitcnt lgkmcnt(3)
    v_mfma_f32_16x16x32_bf16 v[64:67], v[28:31], v[124:127], v[64:67]
    ds_read_b128 v[24:27], v4 offset:4096
    v_mfma_f32_16x16x32_bf16 v[68:71], v[28:31], v[140:143], v[68:71]
    v_mfma_f32_16x16x32_bf16 v[72:75], v[28:31], v[156:159], v[72:75]
    s_waitcnt lgkmcnt(3)
    v_mfma_f32_16x16x32_bf16 v[76:79], v[32:35], v[112:115], v[40:43]
    v_mfma_f32_16x16x32_bf16 v[80:83], v[32:35], v[128:131], v[44:47]
    v_mfma_f32_16x16x32_bf16 v[84:87], v[32:35], v[144:147], v[48:51]
    s_waitcnt lgkmcnt(2)
    v_mfma_f32_16x16x32_bf16 v[76:79], v[16:19], v[116:119], v[76:79]
    v_mfma_f32_16x16x32_bf16 v[80:83], v[16:19], v[132:135], v[80:83]
    v_mfma_f32_16x16x32_bf16 v[84:87], v[16:19], v[148:151], v[84:87]
    s_waitcnt lgkmcnt(1)
    v_mfma_f32_16x16x32_bf16 v[76:79], v[20:23], v[120:123], v[76:79]
    v_mfma_f32_16x16x32_bf16 v[80:83], v[20:23], v[136:139], v[80:83]
    v_mfma_f32_16x16x32_bf16 v[84:87], v[20:23], v[152:155], v[84:87]
    s_waitcnt lgkmcnt(0)
    v_mfma_f32_16x16x32_bf16 v[76:79], v[24:27], v[124:127], v[76:79]
    v_mfma_f32_16x16x32_bf16 v[80:83], v[24:27], v[140:143], v[80:83]
    v_mfma_f32_16x16x32_bf16 v[84:87], v[24:27], v[156:159], v[84:87]
    s_nop 7
    s_branch L_P0
L_fin:
L_end:
    s_endpgm
.section .rodata,"a"
.p2align 6
.amdhsa_kernel concat_heads__mha_block_cached__gqa_block_cached__near_ridge_kernel
  .amdhsa_next_free_vgpr 256
  .amdhsa_next_free_sgpr 102
  .amdhsa_accum_offset 160
  .amdhsa_group_segment_fixed_size 0
  .amdhsa_kernarg_size 104
  .amdhsa_user_sgpr_count 2
  .amdhsa_user_sgpr_kernarg_segment_ptr 1
  .amdhsa_system_sgpr_workgroup_id_x 1
.end_amdhsa_kernel
.text
```
